```python
import torch

def _softmax(x, axis=-1):
    return torch.softmax(x, dim=axis)
def _gelu(x):
    return torch.nn.functional.gelu(x, approximate="tanh")
def _silu(x):
    return torch.nn.functional.silu(x)
def _sigmoid(x):
    return torch.sigmoid(x)
def _layernorm(x, axis=-1, eps=1e-5):
    m = x.mean(dim=axis, keepdim=True)
    v = x.var(dim=axis, keepdim=True, unbiased=False)
    return (x - m) / torch.sqrt(v + eps)
def _scatter_add(tgt, idx, src, axis=0):
    return tgt.clone().index_add_(axis, idx, src)
def _segment_sum(src, seg, n):
    out = torch.zeros((n,) + src.shape[1:], dtype=src.dtype)
    return out.index_add_(0, seg, src)
def _pad(x, pw):
    flat = tuple(v for pair in reversed(pw) for v in pair)
    return torch.nn.functional.pad(x, flat)

kernel_name = 'interleave_layers__sliding_local_dilated__dense_activation_squared_relu__prompt'

def setup_inputs():

    _w = (lambda a: (lambda t: t.to(torch.bfloat16) if t.is_floating_point() else t)(torch.as_tensor(a)))
    def _A_setup():
        B, S, D = 1, 2048, 640
        return {
            "x": _w((lambda *s: torch.randn(*s, dtype=torch.bfloat16) * 0.05)(B, S, D)),
            "wqkv": _w((lambda *s: torch.randn(*s, dtype=torch.bfloat16) * 0.05)(D, 3 * D)),
            "wo": _w((lambda *s: torch.randn(*s, dtype=torch.bfloat16) * 0.05)(D, D)),
        }
    _A_in = _A_setup()

    def _B_setup():
        B, S, D, F = 1, 2048, 640, 1728
        return {
            "x": _w((lambda *s: torch.randn(*s, dtype=torch.bfloat16) * 0.05)(B, S, D)),
            "w1": _w((lambda *s: torch.randn(*s, dtype=torch.bfloat16) * 0.05)(D, F)),
            "b1": _w((lambda *s: torch.randn(*s, dtype=torch.bfloat16) * 0.2)(F)),
            "w2": _w((lambda *s: torch.randn(*s, dtype=torch.bfloat16) * 0.05)(F, D)),
            "b2": _w((lambda *s: torch.randn(*s, dtype=torch.bfloat16) * 0.8)(D)),
        }
    _B_in = _B_setup()

    return {
        "A_x": _A_in["x"],
        "A_wqkv": _A_in["wqkv"],
        "A_wo": _A_in["wo"],
        "B_x": _B_in["x"],
        "B_w1": _B_in["w1"],
        "B_b1": _B_in["b1"],
        "B_w2": _B_in["w2"],
        "B_b2": _B_in["b2"],
    }

def reference(A_x, A_wqkv, A_wo, B_x, B_w1, B_b1, B_w2, B_b2):
    def _A_ref(x, wqkv, wo):
        B, S, D = x.shape
        H = 32; Dh = D // H
        W, dil = 8, 2
        qkv = (lambda x, *d: x.permute(*d))((x @ wqkv).reshape(B, S, 3, H, Dh), 2, 0, 3, 1, 4)
        q, k, v = qkv[0], qkv[1], qkv[2]
        scale = Dh ** -0.5
        pos = torch.arange(S)
        off = torch.arange(W) * dil
        idx = pos[:, None] - off[None, :]
        mask = idx >= 0
        idx_c = torch.where(mask, idx, 0).reshape(-1)
        kg = k[:, :, idx_c, :].reshape(B, H, S, W, Dh)
        vg = v[:, :, idx_c, :].reshape(B, H, S, W, Dh)
        logits = torch.einsum("bhsd,bhswd->bhsw", q, kg) * scale
        logits = torch.where(mask[None, None, :, :], logits, -1e9)
        attn = _softmax(logits, axis=-1)
        o = torch.einsum("bhsw,bhswd->bhsd", attn, vg)
        return (lambda x, *d: x.permute(*d))(o, 0, 2, 1, 3).reshape(B, S, D) @ wo

    def _B_ref(x, w1, b1, w2, b2):
        h = torch.einsum("bsd,df->bsf", x, w1) + b1
        zero = torch.zeros_like(h)
        r = torch.where(h > zero, h, zero)
        h = r * r
        out = torch.einsum("bsf,fd->bsd", h, w2) + b2
        return out

    x = A_x
    x = x + _A_ref(_layernorm(x, axis=-1), A_wqkv, A_wo)
    x = x + _B_ref(_layernorm(x, axis=-1), B_w1, B_b1, B_w2, B_b2)
    x = x + _A_ref(_layernorm(x, axis=-1), A_wqkv, A_wo)
    x = x + _B_ref(_layernorm(x, axis=-1), B_w1, B_b1, B_w2, B_b2)
    return x
```

```asm
; @launch grid=(256,1,1) block=(256,1,1) lds=163840
.amdgcn_target "amdgcn-amd-amdhsa--gfx950"
.text
.globl interleave_layers__sliding_local_dilated__dense_activation_squared_relu__prompt_kernel
.p2align 8
.type interleave_layers__sliding_local_dilated__dense_activation_squared_relu__prompt_kernel,@function
interleave_layers__sliding_local_dilated__dense_activation_squared_relu__prompt_kernel:
    s_cmp_ge_u32 s2, 256
    s_cbranch_scc1 k_end
    s_load_dwordx16 s[64:79], s[0:1], 0
    s_load_dwordx4 s[80:83], s[0:1], 64
    s_load_dwordx2 s[4:5], s[0:1], 80
    v_lshrrev_b32 v1, 6, v0
    v_and_b32 v0, 63, v0
    v_readfirstlane_b32 s22, v1
    v_lshlrev_b32 v1, 4, v0
    v_lshlrev_b32 v62, 2, v0
    v_mov_b32 v63, 0
    s_mov_b32 s24, 0
    s_and_b32 s3, s2, 7
    s_lshr_b32 s21, s2, 3
    s_lshr_b32 s20, s21, 4
    s_lshl_b32 s3, s3, 1
    s_add_u32 s20, s20, s3
    s_and_b32 s21, s21, 15
    s_mov_b32 s23, 0
    s_and_b32 s25, s21, 7
    s_lshr_b32 s26, s21, 3
    s_lshl_b32 s26, s26, 2
    s_add_u32 s26, s26, s22
    s_lshl_b32 s31, s20, 3
    s_add_u32 s31, s31, s26
    s_mul_i32 s29, s31, 20480
    s_mul_i32 s3, s25, 2560
    s_add_u32 s29, s29, s3
    s_lshl_b32 s31, s31, 10
    s_lshl_b32 s3, s25, 7
    s_add_u32 s31, s31, s3
    s_mul_i32 s34, s25, 160
    s_and_b32 s3, s20, 7
    s_lshl_b32 s3, s3, 7
    s_lshl_b32 s32, s26, 4
    s_add_u32 s3, s3, s32
    s_lshl_b32 s3, s3, 1
    s_lshr_b32 s32, s20, 3
    s_add_u32 s3, s3, s32
    s_mul_i32 s3, s3, 1280
    s_add_u32 s32, s3, s34
    v_and_b32 v64, 15, v0
    v_mul_u32_u24 v64, 2560, v64
    v_lshrrev_b32 v65, 4, v0
    v_lshl_add_u32 v64, v65, 3, v64
    s_getreg_b32 s27, hwreg(HW_REG_XCC_ID)
    s_and_b32 s27, s27, 15
    s_waitcnt lgkmcnt(0)
    s_mov_b32 s12, s64
    s_and_b32 s13, s65, 0xffff
    s_mov_b32 s14, 2621440
    s_mov_b32 s15, 0x20000
    s_and_b32 s5, s5, 0xffff
    s_mov_b32 s6, 268435456
    s_mov_b32 s7, 0x20000
    s_mov_b32 s84, s82
    s_and_b32 s85, s83, 0xffff
    s_mov_b32 s86, 256
    s_mov_b32 s87, 0x20000
    s_lshl_b32 s3, s2, 2
    s_add_u32 s3, s3, s22
    s_cmp_lg_u32 s3, 0
    s_cbranch_scc1 no_nonce_1
    s_memrealtime s[40:41]
    s_waitcnt lgkmcnt(0)
    s_lshl_b32 s41, s41, 1
    s_or_b32 s41, s41, 1
    v_mov_b32 v94, s40
    v_mov_b32 v95, s41
    s_mov_b64 exec, 1
    buffer_store_dwordx2 v[94:95], v63, s[84:87], 0 offen offset:128 sc1
    s_mov_b64 exec, -1
    s_nop 1
no_nonce_1:
    buffer_load_dwordx2 v[36:37], v64, s[12:15], s32 offen offset:0
    buffer_load_dwordx2 v[38:39], v64, s[12:15], s32 offen offset:32
    buffer_load_dwordx2 v[40:41], v64, s[12:15], s32 offen offset:64
    buffer_load_dwordx2 v[42:43], v64, s[12:15], s32 offen offset:96
    buffer_load_dwordx2 v[44:45], v64, s[12:15], s32 offen offset:128
    buffer_load_dwordx2 v[94:95], v63, s[84:87], 0 offen offset:128 sc1
    s_getpc_b64 s[8:9]
code_ref:
    s_mov_b32 s10, code_end-code_ref
    s_mov_b32 s11, 0x20000
    s_and_b32 s9, s9, 0xffff
    v_lshlrev_b32 v96, 7, v0
    s_lshl_b32 s3, s22, 13
    s_bfe_u32 s40, s2, 0x20003
    v_bfe_u32 v97, v0, 4, 2
    v_mov_b32 v98, 0x40000000
    v_cmp_eq_u32 vcc, s40, v97
    s_nop 1
    v_cndmask_b32 v96, v98, v96, vcc
    buffer_load_dword v97, v96, s[8:11], s3 offen
    s_lshl_b32 s48, s22, 8
    s_add_u32 s48, s48, s2
    s_lshl_b32 s49, s22, 13
    v_lshrrev_b32 v88, 2, v0
    v_and_b32 v89, 3, v0
    s_cmp_lt_u32 s48, 320
    s_cselect_b32 s55, 0, 1073741824
    s_cselect_b32 s48, s48, 0
    s_mul_i32 s50, s48, 3277
    s_lshr_b32 s50, s50, 16
    s_mul_i32 s51, s50, 20
    s_sub_u32 s51, s48, s51
    s_mov_b32 s8, s66
    s_and_b32 s9, s67, 0xffff
    s_mov_b32 s10, 2457600
    s_mov_b32 s11, 0x20000
    s_cmp_lg_u32 s55, 0
    s_cbranch_scc1 no_wq_2
    v_and_b32 v70, 15, v0
    v_lshrrev_b32 v71, 4, v0
    v_mul_u32_u24 v71, 3840, v71
    v_lshl_add_u32 v71, v70, 4, v71
    v_mov_b32 v72, 1200
    v_cmp_le_u32 vcc, 5, v70
    s_nop 1
    v_cndmask_b32 v73, 0, v72, vcc
    v_add_u32 v71, v71, v73
    v_cmp_le_u32 vcc, 10, v70
    s_nop 1
    v_cndmask_b32 v73, 0, v72, vcc
    v_add_u32 v71, v71, v73
    v_mov_b32 v72, 0x40000000
    v_cmp_eq_u32 vcc, 15, v70
    s_nop 1
    v_cndmask_b32 v71, v71, v72, vcc
    s_mul_i32 s52, s50, 80
    s_lshl_b32 s40, s51, 2
    s_add_u32 s40, s40, 0
    s_mul_i32 s43, s40, 205
    s_lshr_b32 s43, s43, 11
    s_mul_i32 s41, s43, 10
    s_sub_u32 s42, s40, s41
    s_mul_i32 s43, s43, 80
    s_lshr_b32 s41, s42, 2
    s_lshl_b32 s41, s41, 4
    s_lshl_b32 s3, s42, 2
    s_add_u32 s41, s41, s3
    s_lshl_b32 s3, s42, 3
    s_cmp_lt_u32 s42, 8
    s_cselect_b32 s41, s41, s3
    s_cselect_b32 s42, 16, 4
    s_add_u32 s41, s41, s43
    s_mul_i32 s53, s41, 3840
    s_add_u32 m0, s49, 0
    s_add_u32 s53, s53, s52
    buffer_load_dwordx4 v71, s[8:11], s53 offen lds
    s_add_u32 s41, s41, s42
    s_mul_i32 s53, s41, 3840
    s_add_u32 m0, s49, 4096
    s_add_u32 s53, s53, s52
    buffer_load_dwordx4 v71, s[8:11], s53 offen lds
    s_lshl_b32 s40, s51, 2
    s_add_u32 s40, s40, 1
    s_mul_i32 s43, s40, 205
    s_lshr_b32 s43, s43, 11
    s_mul_i32 s41, s43, 10
    s_sub_u32 s42, s40, s41
    s_mul_i32 s43, s43, 80
    s_lshr_b32 s41, s42, 2
    s_lshl_b32 s41, s41, 4
    s_lshl_b32 s3, s42, 2
    s_add_u32 s41, s41, s3
    s_lshl_b32 s3, s42, 3
    s_cmp_lt_u32 s42, 8
    s_cselect_b32 s41, s41, s3
    s_cselect_b32 s42, 16, 4
    s_add_u32 s41, s41, s43
    s_mul_i32 s53, s41, 3840
    s_add_u32 m0, s49, 1024
    s_add_u32 s53, s53, s52
    buffer_load_dwordx4 v71, s[8:11], s53 offen lds
    s_add_u32 s41, s41, s42
    s_mul_i32 s53, s41, 3840
    s_add_u32 m0, s49, 5120
    s_add_u32 s53, s53, s52
    buffer_load_dwordx4 v71, s[8:11], s53 offen lds
    s_lshl_b32 s40, s51, 2
    s_add_u32 s40, s40, 2
    s_mul_i32 s43, s40, 205
    s_lshr_b32 s43, s43, 11
    s_mul_i32 s41, s43, 10
    s_sub_u32 s42, s40, s41
    s_mul_i32 s43, s43, 80
    s_lshr_b32 s41, s42, 2
    s_lshl_b32 s41, s41, 4
    s_lshl_b32 s3, s42, 2
    s_add_u32 s41, s41, s3
    s_lshl_b32 s3, s42, 3
    s_cmp_lt_u32 s42, 8
    s_cselect_b32 s41, s41, s3
    s_cselect_b32 s42, 16, 4
    s_add_u32 s41, s41, s43
    s_mul_i32 s53, s41, 3840
    s_add_u32 m0, s49, 2048
    s_add_u32 s53, s53, s52
    buffer_load_dwordx4 v71, s[8:11], s53 offen lds
    s_add_u32 s41, s41, s42
    s_mul_i32 s53, s41, 3840
    s_add_u32 m0, s49, 6144
    s_add_u32 s53, s53, s52
    buffer_load_dwordx4 v71, s[8:11], s53 offen lds
    s_lshl_b32 s40, s51, 2
    s_add_u32 s40, s40, 3
    s_mul_i32 s43, s40, 205
    s_lshr_b32 s43, s43, 11
    s_mul_i32 s41, s43, 10
    s_sub_u32 s42, s40, s41
    s_mul_i32 s43, s43, 80
    s_lshr_b32 s41, s42, 2
    s_lshl_b32 s41, s41, 4
    s_lshl_b32 s3, s42, 2
    s_add_u32 s41, s41, s3
    s_lshl_b32 s3, s42, 3
    s_cmp_lt_u32 s42, 8
    s_cselect_b32 s41, s41, s3
    s_cselect_b32 s42, 16, 4
    s_add_u32 s41, s41, s43
    s_mul_i32 s53, s41, 3840
    s_add_u32 m0, s49, 3072
    s_add_u32 s53, s53, s52
    buffer_load_dwordx4 v71, s[8:11], s53 offen lds
    s_add_u32 s41, s41, s42
    s_mul_i32 s53, s41, 3840
    s_add_u32 m0, s49, 7168
    s_add_u32 s53, s53, s52
    buffer_load_dwordx4 v71, s[8:11], s53 offen lds
    v_lshlrev_b32 v74, 8, v88
    v_add_u32 v74, s49, v74
    v_lshlrev_b32 v75, 3, v89
    s_mov_b32 s3, 0x7050200
    v_bfe_u32 v76, s3, v75, 8
    v_lshl_add_u32 v76, v76, 3, v74
    s_mov_b32 s3, 0x8060301
    v_bfe_u32 v77, s3, v75, 8
    v_lshl_add_u32 v77, v77, 3, v74
    s_mov_b32 s3, 0x140c0a04
    v_bfe_u32 v78, s3, v75, 8
    v_lshl_add_u32 v78, v78, 3, v74
    s_mov_b32 s3, 0x150d0b1e
    v_bfe_u32 v79, s3, v75, 8
    v_lshl_add_u32 v79, v79, 3, v74
    s_mov_b32 s3, 0x110f0e16
    v_bfe_u32 v80, s3, v75, 8
    v_lshl_add_u32 v80, v80, 3, v74
    s_mov_b32 s3, 0x12101817
    v_bfe_u32 v81, s3, v75, 8
    v_lshl_add_u32 v81, v81, 3, v74
    s_mov_b32 s3, 0x9131b19
    v_bfe_u32 v82, s3, v75, 8
    v_lshl_add_u32 v82, v82, 3, v74
    s_mov_b32 s3, 0x1e1d1c1a
    v_bfe_u32 v83, s3, v75, 8
    v_lshl_add_u32 v83, v83, 3, v74
    s_waitcnt vmcnt(8)
    s_branch xgo_3
    s_nop 2
no_wq_2:
    s_waitcnt vmcnt(0)
    s_nop 0
xgo_3:
    s_mov_b32 s16, s4
    s_and_b32 s17, s5, 0xffff
    s_mov_b32 s18, 268435456
    s_mov_b32 s19, 0x20000
    v_and_b32 v68, 15, v0
    v_lshlrev_b32 v68, 4, v68
    v_lshrrev_b32 v69, 5, v0
    v_lshl_add_u32 v68, v69, 8, v68
    v_bfe_u32 v69, v0, 4, 1
    v_lshl_add_u32 v68, v69, 3, v68
    v_lshlrev_b32 v69, 3, v0
    v_mov_b32 v64, 0x40000000
    v_cmp_gt_u32 vcc, 16, v0
    s_nop 1
    v_cndmask_b32 v69, v64, v69, vcc
    s_add_u32 s36, s29, 7864320
    s_add_u32 s37, s31, 37748736
    buffer_store_dwordx4 v[36:39], v1, s[4:7], s36 offen sc1
    buffer_store_dwordx4 v[40:43], v1, s[4:7], s36 offen offset:1024 sc1
    buffer_store_dwordx2 v[44:45], v68, s[4:7], s36 offen offset:2048 sc1
    s_mov_b32 s39, 0x3f803f80
    v_dot2_f32_bf16 v64, v36, s39, 0
    v_dot2_f32_bf16 v65, v36, v36, 0
    v_dot2_f32_bf16 v64, v37, s39, v64
    v_dot2_f32_bf16 v65, v37, v37, v65
    v_dot2_f32_bf16 v64, v38, s39, v64
    v_dot2_f32_bf16 v65, v38, v38, v65
    v_dot2_f32_bf16 v64, v39, s39, v64
    v_dot2_f32_bf16 v65, v39, v39, v65
    v_dot2_f32_bf16 v64, v40, s39, v64
    v_dot2_f32_bf16 v65, v40, v40, v65
    v_dot2_f32_bf16 v64, v41, s39, v64
    v_dot2_f32_bf16 v65, v41, v41, v65
    v_dot2_f32_bf16 v64, v42, s39, v64
    v_dot2_f32_bf16 v65, v42, v42, v65
    v_dot2_f32_bf16 v64, v43, s39, v64
    v_dot2_f32_bf16 v65, v43, v43, v65
    v_dot2_f32_bf16 v64, v44, s39, v64
    v_dot2_f32_bf16 v65, v44, v44, v65
    v_dot2_f32_bf16 v64, v45, s39, v64
    v_dot2_f32_bf16 v65, v45, v45, v65
    s_nop 1
    v_mov_b32 v66, v64
    v_mov_b32 v67, v65
    s_nop 0
    v_permlane16_swap_b32 v64, v66
    v_permlane16_swap_b32 v65, v67
    v_pk_add_f32 v[64:65], v[64:65], v[66:67]
    v_mov_b32 v66, v64
    v_mov_b32 v67, v65
    s_nop 0
    v_permlane32_swap_b32 v64, v66
    v_permlane32_swap_b32 v65, v67
    v_pk_add_f32 v[64:65], v[64:65], v[66:67]
    buffer_store_dwordx2 v[64:65], v69, s[4:7], s37 offen sc1
    v_readfirstlane_b32 s100, v94
    v_readfirstlane_b32 s101, v95
    s_nop 0
    s_cmp_lg_u32 s101, 0
    s_cbranch_scc1 have_nonce_4
    s_mov_b32 s3, 0
    s_nop 0
nonce_5:
    buffer_load_dwordx2 v[94:95], v63, s[84:87], 0 offen offset:128 sc1
    s_add_u32 s3, s3, 1
    s_waitcnt vmcnt(0)
    v_readfirstlane_b32 s100, v94
    v_readfirstlane_b32 s101, v95
    s_cmp_gt_u32 s3, 100000
    s_cbranch_scc1 nonced_6
    s_cmp_eq_u32 s101, 0
    s_cbranch_scc1 nonce_5
    s_nop 0
nonced_6:
have_nonce_4:
    s_lshl_b32 s38, s20, 4
    s_add_u32 s38, s38, s21
    s_lshl_b32 s44, s38, 3
    s_add_u32 s44, s44, 38299648
    s_lshl_b32 s45, s38, 4
    s_add_u32 s45, s45, 38273024
    s_lshl_b32 s46, s38, 3
    s_add_u32 s46, s46, 38277120
    s_cmp_eq_u32 s22, 2
    s_cselect_b32 s44, s44, 1073741824
    s_cselect_b32 s45, s45, 1073741824
    s_cselect_b32 s46, s46, 1073741824
    s_lshl_b32 s38, s38, 2
    s_add_u32 s38, s38, s22
    s_lshl_b32 s38, s38, 3
    s_lshl_b32 s3, s2, 2
    s_add_u32 s3, s3, s22
    s_lshl_b32 s3, s3, 3
    s_add_u32 s28, s3, 38291456
    s_add_u32 s38, s38, 38283264
    s_cmp_lg_u32 s55, 0
    s_cbranch_scc1 no_wq2_7
    s_mul_i32 s54, s50, 163840
    s_lshl_b32 s3, s51, 11
    s_add_u32 s54, s54, s3
    s_add_u32 s54, s54, 0
    s_waitcnt vmcnt(4)
    ds_read_b64_tr_b16 v[96:97], v76
    ds_read_b64_tr_b16 v[98:99], v76 offset:4096
    ds_read_b64_tr_b16 v[100:101], v77
    ds_read_b64_tr_b16 v[102:103], v77 offset:4096
    ds_read_b64_tr_b16 v[104:105], v78
    ds_read_b64_tr_b16 v[106:107], v78 offset:4096
    ds_read_b64_tr_b16 v[108:109], v79
    ds_read_b64_tr_b16 v[110:111], v79 offset:4096
    ds_read_b64_tr_b16 v[112:113], v80
    ds_read_b64_tr_b16 v[114:115], v80 offset:4096
    ds_read_b64_tr_b16 v[116:117], v81
    ds_read_b64_tr_b16 v[118:119], v81 offset:4096
    ds_read_b64_tr_b16 v[120:121], v82
    ds_read_b64_tr_b16 v[122:123], v82 offset:4096
    ds_read_b64_tr_b16 v[124:125], v83
    ds_read_b64_tr_b16 v[126:127], v83 offset:4096
    s_mul_i32 s3, s50, 12
    s_add_u32 s3, s3, s48
    s_lshl_b32 s3, s3, 3
    s_add_u32 s39, s3, 38279168
    s_waitcnt lgkmcnt(0)
    s_add_u32 s53, s54, 0
    buffer_store_dwordx4 v[96:99], v1, s[4:7], s53 offen sc1
    s_add_u32 s53, s54, 1024
    buffer_store_dwordx4 v[100:103], v1, s[4:7], s53 offen sc1
    s_add_u32 s53, s54, 40960
    buffer_store_dwordx4 v[104:107], v1, s[4:7], s53 offen sc1
    s_add_u32 s53, s54, 41984
    buffer_store_dwordx4 v[108:111], v1, s[4:7], s53 offen sc1
    s_add_u32 s53, s54, 81920
    buffer_store_dwordx4 v[112:115], v1, s[4:7], s53 offen sc1
    s_add_u32 s53, s54, 82944
    buffer_store_dwordx4 v[116:119], v1, s[4:7], s53 offen sc1
    s_add_u32 s53, s54, 122880
    buffer_store_dwordx4 v[120:123], v1, s[4:7], s53 offen sc1
    s_add_u32 s53, s54, 123904
    buffer_store_dwordx4 v[124:127], v1, s[4:7], s53 offen sc1
    s_waitcnt vmcnt(0)
    v_mov_b32 v94, s100
    v_mov_b32 v95, s101
    s_mov_b64 exec, 1
    buffer_store_dwordx2 v[94:95], v63, s[4:7], s39 offen sc1
    s_mov_b64 exec, -1
    s_nop 1
no_wq2_7:
    s_waitcnt vmcnt(1)
    s_cmp_eq_u32 s55, 0
    s_cbranch_scc1 no_wq3_8
    s_waitcnt vmcnt(0)
    s_nop 0
no_wq3_8:
    s_add_u32 s47, s100, s27
    s_add_u32 s47, s47, 1
    v_mov_b32 v94, s47
    v_mov_b32 v95, s101
    s_mov_b64 exec, 1
    buffer_store_dwordx2 v[94:95], v63, s[4:7], s38 offen sc1
    s_mov_b64 exec, -1
    s_mov_b64 exec, 0xf
    buffer_store_dword v63, v62, s[4:7], s45 offen sc1
    s_mov_b64 exec, 0x3
    buffer_store_dword v63, v62, s[4:7], s46 offen sc1
    s_mov_b64 exec, -1
    s_lshl_b32 s40, s21, 2
    s_add_u32 s40, s40, s22
    s_mov_b32 s12, s80
    s_and_b32 s13, s81, 0xffff
    s_mov_b32 s14, 2621440
    s_mov_b32 s15, 0x20000
    s_min_u32 s92, s40, 53
    s_mul_i32 s88, s92, 40960
    s_add_u32 s88, s88, 3440640
    s_mul_i32 s41, s25, 20
    s_mul_i32 s3, s22, 5
    s_add_u32 s41, s41, s3
    s_mul_i32 s41, s41, 5120
    s_add_u32 s63, s41, 2621440
    s_mul_i32 s59, s22, 14
    s_cmp_eq_u32 s22, 3
    s_cselect_b32 s3, 1, 0
    s_sub_u32 s59, s59, s3
    s_mul_i32 s41, s25, 54
    s_add_u32 s41, s41, s59
    s_mul_i32 s41, s41, 5120
    s_add_u32 s89, s41, 5652480
    s_add_u32 s41, s89, 66560
    s_cmp_ge_u32 s22, 2
    s_cselect_b32 s90, 1073741824, s41
    s_lshl_b32 s61, s20, 8
    s_add_u32 s61, s61, 38273024
    s_lshl_b32 s3, s40, 2
    s_add_u32 s60, s61, s3
    s_mov_b32 s95, 0
    s_mov_b32 s91, 0
    s_and_b32 s3, s20, 7
    s_cmp_eq_u32 s3, 0
    s_cselect_b32 s41, 0, 1
    s_sub_u32 s41, s20, s41
    s_lshl_b32 s41, s41, 3
    s_add_u32 s41, s41, 7
    s_mul_i32 s93, s41, 20480
    s_add_u32 s93, s93, 7864320
    s_lshl_b32 s94, s41, 10
    s_add_u32 s94, s94, 37748736
    v_and_b32 v70, 15, v0
    v_lshrrev_b32 v71, 4, v0
    v_lshlrev_b32 v71, 2, v71
    v_sub_u32 v71, v71, v70
    v_mov_b32 v72, 0xf149f2ca
    v_mov_b32 v73, 0xffff
    v_mov_b32 v74, 0xffff0000
    s_and_b32 s3, s20, 7
    s_or_b32 s3, s3, s22
    s_cmp_lg_u32 s3, 0
    s_cselect_b64 s[42:43], -1, 0
    v_add_u32 v75, 7, v71
    v_cmp_ge_u32 vcc, 7, v75
    s_nop 1
    v_cndmask_b32 v46, v72, 0, vcc
    v_cndmask_b32 v76, 0, v73, vcc
    v_mov_b32 v60, v76
    v_cmp_le_i32 vcc, 16, v75
    s_nop 1
    v_cndmask_b32 v50, v72, 0, vcc
    v_cndmask_b32 v76, 0, v73, vcc
    v_mov_b32 v58, v76
    v_cndmask_b32 v54, v72, v50, s[42:43]
    v_add_u32 v75, 8, v71
    v_cmp_ge_u32 vcc, 7, v75
    s_nop 1
    v_cndmask_b32 v47, v72, 0, vcc
    v_cndmask_b32 v76, 0, v74, vcc
    v_or_b32 v60, v60, v76
    v_cmp_le_i32 vcc, 16, v75
    s_nop 1
    v_cndmask_b32 v51, v72, 0, vcc
    v_cndmask_b32 v76, 0, v74, vcc
    v_or_b32 v58, v58, v76
    v_cndmask_b32 v55, v72, v51, s[42:43]
    v_add_u32 v75, 9, v71
    v_cmp_ge_u32 vcc, 7, v75
    s_nop 1
    v_cndmask_b32 v48, v72, 0, vcc
    v_cndmask_b32 v76, 0, v73, vcc
    v_mov_b32 v61, v76
    v_cmp_le_i32 vcc, 16, v75
    s_nop 1
    v_cndmask_b32 v52, v72, 0, vcc
    v_cndmask_b32 v76, 0, v73, vcc
    v_mov_b32 v59, v76
    v_cndmask_b32 v56, v72, v52, s[42:43]
    v_add_u32 v75, 10, v71
    v_cmp_ge_u32 vcc, 7, v75
    s_nop 1
    v_cndmask_b32 v49, v72, 0, vcc
    v_cndmask_b32 v76, 0, v74, vcc
    v_or_b32 v61, v61, v76
    v_cmp_le_i32 vcc, 16, v75
    s_nop 1
    v_cndmask_b32 v53, v72, 0, vcc
    v_cndmask_b32 v76, 0, v74, vcc
    v_or_b32 v59, v59, v76
    v_cndmask_b32 v57, v72, v53, s[42:43]
    v_lshrrev_b32 v162, 4, v0
    v_lshlrev_b32 v162, 3, v162
    s_mov_b32 s8, s74
    s_and_b32 s9, s75, 0xffff
    s_mov_b32 s10, 3456
    s_mov_b32 s11, 0x20000
    s_lshl_b32 s3, s92, 6
    buffer_load_dwordx2 v[18:19], v162, s[8:11], s3 offen
    buffer_load_dwordx2 v[20:21], v162, s[8:11], s3 offen offset:32
    s_mov_b32 s8, s78
    s_and_b32 s9, s79, 0xffff
    s_mov_b32 s10, 1280
    s_mov_b32 s11, 0x20000
    buffer_load_dwordx2 v[26:27], v162, s[8:11], s34 offen offset:0
    buffer_load_dwordx2 v[28:29], v162, s[8:11], s34 offen offset:32
    buffer_load_dwordx2 v[30:31], v162, s[8:11], s34 offen offset:64
    buffer_load_dwordx2 v[32:33], v162, s[8:11], s34 offen offset:96
    buffer_load_dwordx2 v[34:35], v162, s[8:11], s34 offen offset:128
    s_mul_i32 s48, s2, 5
    v_bfe_u32 v70, v0, 3, 2
    v_and_b32 v71, 7, v0
    v_lshlrev_b32 v71, 4, v71
    v_lshrrev_b32 v72, 5, v0
    s_cmp_ge_u32 s48, 740
    s_cbranch_scc1 pg_w2_10
    s_cmp_ge_u32 s48, 200
    s_cbranch_scc1 pg_w1_9
    s_mov_b32 s8, s68
    s_and_b32 s9, s69, 0xffff
    s_mov_b32 s10, 819200
    s_mov_b32 s11, 0x20000
    s_mov_b32 s42, 1280
    s_mov_b32 s43, 2621440
    s_mov_b32 s44, 20
    s_add_u32 s3, s48, s22
    s_mul_i32 s45, s3, 6554
    s_lshr_b32 s45, s45, 16
    s_mul_i32 s50, s45, 10
    s_sub_u32 s46, s3, s50
    s_lshl_b32 s3, s45, 2
    s_add_u32 s3, s3, 0
    v_add_u32 v73, s3, v72
    v_mul_u32_u24 v84, 205, v73
    v_lshrrev_b32 v84, 10, v84
    v_mul_u32_u24 v84, 20, v84
    v_lshl_add_u32 v76, v73, 2, v84
    v_mov_b32 v77, 20
    s_lshl_b32 s3, s45, 2
    s_add_u32 s3, s3, 2
    v_add_u32 v73, s3, v72
    v_mul_u32_u24 v84, 205, v73
    v_lshrrev_b32 v84, 10, v84
    v_mul_u32_u24 v84, 20, v84
    v_lshl_add_u32 v78, v73, 2, v84
    v_mov_b32 v79, 20
    s_add_u32 s3, s48, 4
    s_mul_i32 s47, s3, 6554
    s_lshr_b32 s47, s47, 16
    s_mul_i32 s50, s47, 10
    s_sub_u32 s35, s3, s50
    s_lshl_b32 s3, s47, 2
    s_add_u32 s3, s3, 0
    v_add_u32 v73, s3, v72
    v_mul_u32_u24 v84, 205, v73
    v_lshrrev_b32 v84, 10, v84
    v_mul_u32_u24 v84, 20, v84
    v_lshl_add_u32 v80, v73, 2, v84
    v_mov_b32 v81, 20
    s_lshl_b32 s3, s47, 2
    s_add_u32 s3, s3, 2
    v_add_u32 v73, s3, v72
    v_mul_u32_u24 v84, 205, v73
    v_lshrrev_b32 v84, 10, v84
    v_mul_u32_u24 v84, 20, v84
    v_lshl_add_u32 v82, v73, 2, v84
    v_mov_b32 v83, 20
    s_branch pg_go_11
    s_nop 3
pg_w1_9:
    s_sub_u32 s48, s48, 200
    s_mov_b32 s8, s72
    s_and_b32 s9, s73, 0xffff
    s_mov_b32 s10, 2211840
    s_mov_b32 s11, 0x20000
    s_mov_b32 s42, 3456
    s_mov_b32 s43, 3440640
    s_mov_b32 s44, 0
    s_add_u32 s3, s48, s22
    s_mul_i32 s45, s3, 2428
    s_lshr_b32 s45, s45, 16
    s_mul_i32 s50, s45, 27
    s_sub_u32 s46, s3, s50
    s_lshl_b32 s3, s45, 2
    s_add_u32 s3, s3, 0
    v_add_u32 v73, s3, v72
    v_mul_u32_u24 v84, 205, v73
    v_lshrrev_b32 v84, 11, v84
    v_mul_u32_u24 v76, 10, v84
    v_sub_u32 v77, v73, v76
    v_mul_u32_u24 v84, 80, v84
    v_lshrrev_b32 v76, 2, v77
    v_lshlrev_b32 v76, 4, v76
    v_lshl_add_u32 v76, v77, 2, v76
    v_lshlrev_b32 v85, 3, v77
    v_cmp_gt_u32 vcc, 8, v77
    s_nop 1
    v_cndmask_b32 v76, v85, v76, vcc
    v_cndmask_b32 v77, 4, 16, vcc
    v_add_u32 v76, v76, v84
    s_lshl_b32 s3, s45, 2
    s_add_u32 s3, s3, 2
    v_add_u32 v73, s3, v72
    v_mul_u32_u24 v84, 205, v73
    v_lshrrev_b32 v84, 11, v84
    v_mul_u32_u24 v78, 10, v84
    v_sub_u32 v79, v73, v78
    v_mul_u32_u24 v84, 80, v84
    v_lshrrev_b32 v78, 2, v79
    v_lshlrev_b32 v78, 4, v78
    v_lshl_add_u32 v78, v79, 2, v78
    v_lshlrev_b32 v85, 3, v79
    v_cmp_gt_u32 vcc, 8, v79
    s_nop 1
    v_cndmask_b32 v78, v85, v78, vcc
    v_cndmask_b32 v79, 4, 16, vcc
    v_add_u32 v78, v78, v84
    s_add_u32 s3, s48, 4
    s_mul_i32 s47, s3, 2428
    s_lshr_b32 s47, s47, 16
    s_mul_i32 s50, s47, 27
    s_sub_u32 s35, s3, s50
    s_lshl_b32 s3, s47, 2
    s_add_u32 s3, s3, 0
    v_add_u32 v73, s3, v72
    v_mul_u32_u24 v84, 205, v73
    v_lshrrev_b32 v84, 11, v84
    v_mul_u32_u24 v80, 10, v84
    v_sub_u32 v81, v73, v80
    v_mul_u32_u24 v84, 80, v84
    v_lshrrev_b32 v80, 2, v81
    v_lshlrev_b32 v80, 4, v80
    v_lshl_add_u32 v80, v81, 2, v80
    v_lshlrev_b32 v85, 3, v81
    v_cmp_gt_u32 vcc, 8, v81
    s_nop 1
    v_cndmask_b32 v80, v85, v80, vcc
    v_cndmask_b32 v81, 4, 16, vcc
    v_add_u32 v80, v80, v84
    s_lshl_b32 s3, s47, 2
    s_add_u32 s3, s3, 2
    v_add_u32 v73, s3, v72
    v_mul_u32_u24 v84, 205, v73
    v_lshrrev_b32 v84, 11, v84
    v_mul_u32_u24 v82, 10, v84
    v_sub_u32 v83, v73, v82
    v_mul_u32_u24 v84, 80, v84
    v_lshrrev_b32 v82, 2, v83
    v_lshlrev_b32 v82, 4, v82
    v_lshl_add_u32 v82, v83, 2, v82
    v_lshlrev_b32 v85, 3, v83
    v_cmp_gt_u32 vcc, 8, v83
    s_nop 1
    v_cndmask_b32 v82, v85, v82, vcc
    v_cndmask_b32 v83, 4, 16, vcc
    v_add_u32 v82, v82, v84
    s_branch pg_go_11
    s_nop 3
pg_w2_10:
    s_sub_u32 s48, s48, 740
    s_mov_b32 s8, s76
    s_and_b32 s9, s77, 0xffff
    s_mov_b32 s10, 2211840
    s_mov_b32 s11, 0x20000
    s_mov_b32 s42, 1280
    s_mov_b32 s43, 5652480
    s_mov_b32 s44, 54
    s_add_u32 s3, s48, s22
    s_mul_i32 s45, s3, 6554
    s_lshr_b32 s45, s45, 16
    s_mul_i32 s50, s45, 10
    s_sub_u32 s46, s3, s50
    s_lshl_b32 s3, s45, 2
    s_add_u32 s3, s3, 0
    v_add_u32 v73, s3, v72
    v_lshrrev_b32 v84, 2, v73
    v_lshlrev_b32 v84, 4, v84
    v_lshl_add_u32 v76, v73, 2, v84
    v_mov_b32 v77, 16
    s_lshl_b32 s3, s45, 2
    s_add_u32 s3, s3, 2
    v_add_u32 v73, s3, v72
    v_lshrrev_b32 v84, 2, v73
    v_lshlrev_b32 v84, 4, v84
    v_lshl_add_u32 v78, v73, 2, v84
    v_mov_b32 v79, 16
    s_add_u32 s3, s48, 4
    s_mul_i32 s47, s3, 6554
    s_lshr_b32 s47, s47, 16
    s_mul_i32 s50, s47, 10
    s_sub_u32 s35, s3, s50
    s_lshl_b32 s3, s47, 2
    s_add_u32 s3, s3, 0
    v_add_u32 v73, s3, v72
    v_lshrrev_b32 v84, 2, v73
    v_lshlrev_b32 v84, 4, v84
    v_lshl_add_u32 v80, v73, 2, v84
    v_mov_b32 v81, 16
    s_lshl_b32 s3, s47, 2
    s_add_u32 s3, s3, 2
    v_add_u32 v73, s3, v72
    v_lshrrev_b32 v84, 2, v73
    v_lshlrev_b32 v84, 4, v84
    v_lshl_add_u32 v82, v73, 2, v84
    v_mov_b32 v83, 16
    s_nop 4
pg_go_11:
    s_cmp_eq_u32 s22, 3
    s_cselect_b32 s55, 0, 1073741824
    v_add_u32 v128, v76, v70
    v_mul_lo_u32 v128, v128, s42
    v_add_u32 v128, v128, v71
    v_add_u32 v129, v78, v70
    v_mul_lo_u32 v129, v129, s42
    v_add_u32 v129, v129, v71
    v_add_u32 v130, v76, v70
    v_add_u32 v130, v130, v77
    v_mul_lo_u32 v130, v130, s42
    v_add_u32 v130, v130, v71
    v_add_u32 v131, v78, v70
    v_add_u32 v131, v131, v79
    v_mul_lo_u32 v131, v131, s42
    v_add_u32 v131, v131, v71
    v_add_u32 v132, v80, v70
    v_mul_lo_u32 v132, v132, s42
    v_add_u32 v132, v132, v71
    v_add_u32 v133, v82, v70
    v_mul_lo_u32 v133, v133, s42
    v_add_u32 v133, v133, v71
    v_add_u32 v134, v80, v70
    v_add_u32 v134, v134, v81
    v_mul_lo_u32 v134, v134, s42
    v_add_u32 v134, v134, v71
    v_add_u32 v135, v82, v70
    v_add_u32 v135, v135, v83
    v_mul_lo_u32 v135, v135, s42
    v_add_u32 v135, v135, v71
    s_lshl_b32 s49, s22, 13
    s_add_u32 s49, s49, 122880
    v_lshlrev_b32 v74, 7, v88
    v_lshl_add_u32 v74, v89, 3, v74
    v_add_u32 v74, s49, v74
    s_lshl_b32 s3, s21, 2
    s_add_u32 s3, s3, s22
    s_mul_i32 s62, s3, 40960
    s_add_u32 s62, s62, 0
    v_lshlrev_b32 v161, 3, v0
    s_lshl_b32 s36, s21, 8
    s_add_u32 s36, s36, 38279168
    s_lshl_b32 s37, s20, 9
    s_add_u32 s37, s37, 38283264
    s_and_b32 s3, s20, 7
    s_cmp_eq_u32 s3, 0
    s_cselect_b32 s38, 0, 512
    s_sub_u32 s38, s37, s38
    s_barrier
    s_lshl_b32 s50, s46, 7
    s_add_u32 m0, s49, 0
    s_nop 0
    buffer_load_dwordx4 v128, s[8:11], s50 offen lds
    s_add_u32 m0, s49, 1024
    s_nop 0
    buffer_load_dwordx4 v129, s[8:11], s50 offen lds
    s_add_u32 m0, s49, 2048
    s_nop 0
    buffer_load_dwordx4 v130, s[8:11], s50 offen lds
    s_add_u32 m0, s49, 3072
    s_nop 0
    buffer_load_dwordx4 v131, s[8:11], s50 offen lds
    s_lshl_b32 s50, s35, 7
    s_add_u32 s50, s50, s55
    s_add_u32 m0, s49, 4096
    s_nop 0
    buffer_load_dwordx4 v132, s[8:11], s50 offen lds
    s_add_u32 m0, s49, 5120
    s_nop 0
    buffer_load_dwordx4 v133, s[8:11], s50 offen lds
    s_add_u32 m0, s49, 6144
    s_nop 0
    buffer_load_dwordx4 v134, s[8:11], s50 offen lds
    s_add_u32 m0, s49, 7168
    s_nop 0
    buffer_load_dwordx4 v135, s[8:11], s50 offen lds
    s_waitcnt vmcnt(0)
    buffer_load_dwordx2 v[64:65], v161, s[4:7], s36 offen sc1
    buffer_load_dwordx2 v[66:67], v161, s[4:7], s37 offen sc1
    buffer_load_dwordx2 v[68:69], v161, s[4:7], s38 offen sc1
    ds_read_b64_tr_b16 v[96:97], v74 offset:0
    ds_read_b64_tr_b16 v[98:99], v74 offset:2048
    ds_read_b64_tr_b16 v[100:101], v74 offset:32
    ds_read_b64_tr_b16 v[102:103], v74 offset:2080
    ds_read_b64_tr_b16 v[104:105], v74 offset:64
    ds_read_b64_tr_b16 v[106:107], v74 offset:2112
    ds_read_b64_tr_b16 v[108:109], v74 offset:96
    ds_read_b64_tr_b16 v[110:111], v74 offset:2144
    ds_read_b64_tr_b16 v[112:113], v74 offset:4096
    ds_read_b64_tr_b16 v[114:115], v74 offset:6144
    ds_read_b64_tr_b16 v[116:117], v74 offset:4128
    ds_read_b64_tr_b16 v[118:119], v74 offset:6176
    ds_read_b64_tr_b16 v[120:121], v74 offset:4160
    ds_read_b64_tr_b16 v[122:123], v74 offset:6208
    ds_read_b64_tr_b16 v[124:125], v74 offset:4192
    ds_read_b64_tr_b16 v[126:127], v74 offset:6240
    s_lshl_b32 s50, s46, 2
    s_add_u32 s50, s50, 0
    s_lshr_b32 s51, s50, 1
    s_mul_i32 s51, s51, 20
    s_add_u32 s51, s51, s45
    s_lshl_b32 s51, s51, 1
    s_add_u32 s51, s51, 0
    s_mul_i32 s52, s50, 205
    s_lshr_b32 s52, s52, 10
    s_mul_i32 s53, s52, 5
    s_sub_u32 s53, s50, s53
    s_mul_i32 s52, s52, s44
    s_add_u32 s52, s52, s45
    s_mul_i32 s52, s52, 5
    s_add_u32 s52, s52, s53
    s_cmp_eq_u32 s44, 0
    s_cselect_b32 s51, s51, s52
    s_lshl_b32 s51, s51, 10
    s_add_u32 s51, s51, s43
    s_waitcnt lgkmcnt(0)
    buffer_store_dwordx4 v[96:99], v1, s[4:7], s51 offen sc1
    s_lshl_b32 s50, s46, 2
    s_add_u32 s50, s50, 1
    s_lshr_b32 s51, s50, 1
    s_mul_i32 s51, s51, 20
    s_add_u32 s51, s51, s45
    s_lshl_b32 s51, s51, 1
    s_add_u32 s51, s51, 1
    s_mul_i32 s52, s50, 205
    s_lshr_b32 s52, s52, 10
    s_mul_i32 s53, s52, 5
    s_sub_u32 s53, s50, s53
    s_mul_i32 s52, s52, s44
    s_add_u32 s52, s52, s45
    s_mul_i32 s52, s52, 5
    s_add_u32 s52, s52, s53
    s_cmp_eq_u32 s44, 0
    s_cselect_b32 s51, s51, s52
    s_lshl_b32 s51, s51, 10
    s_add_u32 s51, s51, s43
    buffer_store_dwordx4 v[100:103], v1, s[4:7], s51 offen sc1
    s_lshl_b32 s50, s46, 2
    s_add_u32 s50, s50, 2
    s_lshr_b32 s51, s50, 1
    s_mul_i32 s51, s51, 20
    s_add_u32 s51, s51, s45
    s_lshl_b32 s51, s51, 1
    s_add_u32 s51, s51, 0
    s_mul_i32 s52, s50, 205
    s_lshr_b32 s52, s52, 10
    s_mul_i32 s53, s52, 5
    s_sub_u32 s53, s50, s53
    s_mul_i32 s52, s52, s44
    s_add_u32 s52, s52, s45
    s_mul_i32 s52, s52, 5
    s_add_u32 s52, s52, s53
    s_cmp_eq_u32 s44, 0
    s_cselect_b32 s51, s51, s52
    s_lshl_b32 s51, s51, 10
    s_add_u32 s51, s51, s43
    buffer_store_dwordx4 v[104:107], v1, s[4:7], s51 offen sc1
    s_lshl_b32 s50, s46, 2
    s_add_u32 s50, s50, 3
    s_lshr_b32 s51, s50, 1
    s_mul_i32 s51, s51, 20
    s_add_u32 s51, s51, s45
    s_lshl_b32 s51, s51, 1
    s_add_u32 s51, s51, 1
    s_mul_i32 s52, s50, 205
    s_lshr_b32 s52, s52, 10
    s_mul_i32 s53, s52, 5
    s_sub_u32 s53, s50, s53
    s_mul_i32 s52, s52, s44
    s_add_u32 s52, s52, s45
    s_mul_i32 s52, s52, 5
    s_add_u32 s52, s52, s53
    s_cmp_eq_u32 s44, 0
    s_cselect_b32 s51, s51, s52
    s_lshl_b32 s51, s51, 10
    s_add_u32 s51, s51, s43
    buffer_store_dwordx4 v[108:111], v1, s[4:7], s51 offen sc1
    s_lshl_b32 s50, s35, 2
    s_add_u32 s50, s50, 0
    s_lshr_b32 s51, s50, 1
    s_mul_i32 s51, s51, 20
    s_add_u32 s51, s51, s47
    s_lshl_b32 s51, s51, 1
    s_add_u32 s51, s51, 0
    s_mul_i32 s52, s50, 205
    s_lshr_b32 s52, s52, 10
    s_mul_i32 s53, s52, 5
    s_sub_u32 s53, s50, s53
    s_mul_i32 s52, s52, s44
    s_add_u32 s52, s52, s47
    s_mul_i32 s52, s52, 5
    s_add_u32 s52, s52, s53
    s_cmp_eq_u32 s44, 0
    s_cselect_b32 s51, s51, s52
    s_lshl_b32 s51, s51, 10
    s_add_u32 s51, s51, s43
    s_add_u32 s51, s51, s55
    buffer_store_dwordx4 v[112:115], v1, s[4:7], s51 offen sc1
    s_lshl_b32 s50, s35, 2
    s_add_u32 s50, s50, 1
    s_lshr_b32 s51, s50, 1
    s_mul_i32 s51, s51, 20
    s_add_u32 s51, s51, s47
    s_lshl_b32 s51, s51, 1
    s_add_u32 s51, s51, 1
    s_mul_i32 s52, s50, 205
    s_lshr_b32 s52, s52, 10
    s_mul_i32 s53, s52, 5
    s_sub_u32 s53, s50, s53
    s_mul_i32 s52, s52, s44
    s_add_u32 s52, s52, s47
    s_mul_i32 s52, s52, 5
    s_add_u32 s52, s52, s53
    s_cmp_eq_u32 s44, 0
    s_cselect_b32 s51, s51, s52
    s_lshl_b32 s51, s51, 10
    s_add_u32 s51, s51, s43
    s_add_u32 s51, s51, s55
    buffer_store_dwordx4 v[116:119], v1, s[4:7], s51 offen sc1
    s_lshl_b32 s50, s35, 2
    s_add_u32 s50, s50, 2
    s_lshr_b32 s51, s50, 1
    s_mul_i32 s51, s51, 20
    s_add_u32 s51, s51, s47
    s_lshl_b32 s51, s51, 1
    s_add_u32 s51, s51, 0
    s_mul_i32 s52, s50, 205
    s_lshr_b32 s52, s52, 10
    s_mul_i32 s53, s52, 5
    s_sub_u32 s53, s50, s53
    s_mul_i32 s52, s52, s44
    s_add_u32 s52, s52, s47
    s_mul_i32 s52, s52, 5
    s_add_u32 s52, s52, s53
    s_cmp_eq_u32 s44, 0
    s_cselect_b32 s51, s51, s52
    s_lshl_b32 s51, s51, 10
    s_add_u32 s51, s51, s43
    s_add_u32 s51, s51, s55
    buffer_store_dwordx4 v[120:123], v1, s[4:7], s51 offen sc1
    s_lshl_b32 s50, s35, 2
    s_add_u32 s50, s50, 3
    s_lshr_b32 s51, s50, 1
    s_mul_i32 s51, s51, 20
    s_add_u32 s51, s51, s47
    s_lshl_b32 s51, s51, 1
    s_add_u32 s51, s51, 1
    s_mul_i32 s52, s50, 205
    s_lshr_b32 s52, s52, 10
    s_mul_i32 s53, s52, 5
    s_sub_u32 s53, s50, s53
    s_mul_i32 s52, s52, s44
    s_add_u32 s52, s52, s47
    s_mul_i32 s52, s52, 5
    s_add_u32 s52, s52, s53
    s_cmp_eq_u32 s44, 0
    s_cselect_b32 s51, s51, s52
    s_lshl_b32 s51, s51, 10
    s_add_u32 s51, s51, s43
    s_add_u32 s51, s51, s55
    buffer_store_dwordx4 v[124:127], v1, s[4:7], s51 offen sc1
    s_nop 1
pass_loop:
    s_mul_i32 s44, s22, 5120
    s_mul_i32 s45, s20, 163840
    s_add_u32 s45, s45, s91
    s_lshr_b32 s50, s22, 0
    s_and_b32 s51, s22, 0
    s_mul_i32 s51, s51, 5120
    s_mul_i32 s46, s50, 20480
    s_add_u32 s46, s46, s45
    s_add_u32 s46, s46, 7843840
    s_cmp_eq_u32 s50, 0
    s_cselect_b32 s46, s93, s46
    s_add_u32 s46, s46, s51
    s_add_u32 s45, s45, s44
    s_mul_i32 s47, s22, 4352
    s_add_u32 s47, s47, 122880
    v_and_b32 v104, 15, v0
    v_mul_u32_u24 v104, 272, v104
    v_add_u32 v104, s47, v104
    v_lshrrev_b32 v105, 4, v0
    v_lshlrev_b32 v105, 3, v105
    s_mov_b32 s3, 0x10040100
    v_bfe_u32 v152, s3, v105, 8
    v_lshl_add_u32 v152, v152, 4, v104
    s_mov_b32 s3, 0x100f0302
    v_bfe_u32 v153, s3, v105, 8
    v_lshl_add_u32 v153, v153, 4, v104
    s_mov_b32 s3, 0x9090605
    v_bfe_u32 v154, s3, v105, 8
    v_lshl_add_u32 v154, v154, 4, v104
    v_lshrrev_b32 v156, 2, v0
    v_mul_u32_u24 v156, 272, v156
    v_add_u32 v156, s47, v156
    v_and_b32 v104, 3, v0
    v_lshl_add_u32 v155, v104, 3, v156
    v_mov_b32 v104, 0x40000000
    v_cmp_gt_u32 vcc, 16, v0
    s_nop 1
    v_cndmask_b32 v157, v104, v1, vcc
    s_lshl_b32 s47, s20, 3
    s_add_u32 s47, s47, s22
    s_mul_i32 s47, s47, 20480
    s_mul_i32 s3, s21, 1280
    s_add_u32 s47, s47, s3
    s_mul_i32 s3, s24, 2621440
    s_add_u32 s47, s47, s3
    s_add_u32 s47, s47, 18350080
    s_mov_b32 s48, 0x3ea52b5c
    v_lshrrev_b32 v104, 4, v0
    s_lshl_b32 s3, s22, 2
    v_add_u32 v104, s3, v104
    v_and_b32 v105, 15, v0
    v_lshlrev_b32 v151, 3, v105
    v_lshl_add_u32 v107, v104, 10, v151
    v_add_u32 v151, 162048, v151
    v_min_u32 v158, 11, v104
    v_lshl_add_u32 v158, v158, 7, v151
    s_lshl_b32 s40, s20, 13
    s_lshl_b32 s3, s24, 18
    s_add_u32 s40, s40, s3
    s_add_u32 s40, s40, 37747712
    v_mov_b32 v108, s40
    v_mov_b32 v109, s94
    v_cmp_eq_u32 vcc, 0, v104
    s_nop 1
    v_cndmask_b32 v108, v108, v109, vcc
    v_mov_b32 v109, 0x40000000
    v_cmp_gt_u32 vcc, 9, v104
    s_nop 1
    v_cndmask_b32 v108, v109, v108, vcc
    v_add_u32 v107, v107, v108
    v_mov_b32 v148, v1
    v_add_u32 v149, 61440, v1
    v_mul_u32_u24 v150, 272, v105
    v_lshl_add_u32 v150, v104, 4, v150
    v_add_u32 v150, 122880, v150
    s_mov_b32 s42, 0xbacccccd
    s_mov_b32 s43, 0x3727c5ac
    s_cmp_eq_u32 s24, 0
    s_cbranch_scc1 p1_nowait_12
    s_mov_b32 s3, 0
    s_nop 0
poll_13:
    buffer_load_dword v162, v62, s[4:7], s61 offen offset:0 sc1
    s_add_u32 s3, s3, 1
    s_waitcnt vmcnt(0)
    v_cmp_gt_u32 vcc, s95, v162
    s_cmp_gt_u32 s3, 200000
    s_cbranch_scc1 polld_14
    s_cbranch_vccnz poll_13
    s_nop 1
polld_14:
    s_and_b32 s49, s20, 7
    s_cmp_eq_u32 s49, 0
    s_cbranch_scc1 p1_nohalo_15
    s_lshl_b32 s49, s20, 7
    s_add_u32 s49, s49, 38276992
    s_mov_b64 exec, 0xff
    s_mov_b32 s3, 0
    s_nop 0
poll_16:
    buffer_load_dword v162, v62, s[4:7], s49 offen offset:0 sc1
    s_add_u32 s3, s3, 1
    s_waitcnt vmcnt(0)
    v_cmp_gt_u32 vcc, 1, v162
    s_cmp_gt_u32 s3, 200000
    s_cbranch_scc1 polld_17
    s_cbranch_vccnz poll_16
    s_nop 1
polld_17:
    s_mov_b64 exec, -1
    s_nop 0
p1_nohalo_15:
    s_branch p1_go_18
    s_nop 0
p1_nowait_12:
    s_waitcnt vmcnt(8)
    s_mov_b32 s52, 0
    s_mov_b32 s53, 0x88888888
    s_add_u32 s39, s100, 1
    s_mov_b32 s3, 0
    s_nop 0
dp_19:
    v_cmp_ne_u64 vcc, s[100:101], v[64:65]
    v_subrev_u32 v66, s39, v66
    v_subrev_u32 v68, s39, v68
    s_and_b64 s[50:51], vcc, 0xfffff
    v_cmp_ne_u32 vcc, s101, v67
    s_nop 0
    s_or_b64 s[50:51], s[50:51], vcc
    v_cmp_lt_u32 vcc, 15, v66
    s_nop 0
    s_or_b64 s[50:51], s[50:51], vcc
    v_cmp_ne_u32 vcc, s101, v69
    s_nop 0
    s_and_b64 vcc, vcc, s[52:53]
    s_or_b64 s[50:51], s[50:51], vcc
    v_cmp_lt_u32 vcc, 15, v68
    s_nop 0
    s_and_b64 vcc, vcc, s[52:53]
    s_or_b64 s[50:51], s[50:51], vcc
    s_cmp_eq_u64 s[50:51], 0
    s_cbranch_scc1 dpd_20
    s_add_u32 s3, s3, 1
    s_cmp_gt_u32 s3, 100000
    s_cbranch_scc1 dpd_20
    s_sleep 2
    buffer_load_dwordx2 v[64:65], v161, s[4:7], s36 offen sc1
    buffer_load_dwordx2 v[66:67], v161, s[4:7], s37 offen sc1
    buffer_load_dwordx2 v[68:69], v161, s[4:7], s38 offen sc1
    s_waitcnt vmcnt(0)
    s_branch dp_19
    s_nop 0
dpd_20:
    v_cmp_ne_u32 vcc, s27, v66
    s_nop 0
    s_cmp_eq_u64 vcc, 0
    s_cselect_b32 s23, 1, 0
    s_add_u32 s58, s62, 0
    buffer_load_dwordx4 a[100:103], v1, s[4:7], s58 offen offset:0
    buffer_load_dwordx4 a[104:107], v1, s[4:7], s58 offen offset:1024
    buffer_load_dwordx4 a[108:111], v1, s[4:7], s58 offen offset:2048
    buffer_load_dwordx4 a[112:115], v1, s[4:7], s58 offen offset:3072
    s_add_u32 s58, s62, 4096
    buffer_load_dwordx4 a[116:119], v1, s[4:7], s58 offen offset:0
    buffer_load_dwordx4 a[120:123], v1, s[4:7], s58 offen offset:1024
    buffer_load_dwordx4 a[124:127], v1, s[4:7], s58 offen offset:2048
    buffer_load_dwordx4 a[128:131], v1, s[4:7], s58 offen offset:3072
    s_add_u32 s58, s62, 8192
    buffer_load_dwordx4 a[132:135], v1, s[4:7], s58 offen offset:0
    buffer_load_dwordx4 a[136:139], v1, s[4:7], s58 offen offset:1024
    s_waitcnt vmcnt(10)
    v_mov_b32 v64, s100
    v_mov_b32 v65, s101
    s_mov_b64 exec, 1
    buffer_store_dwordx2 v[64:65], v63, s[4:7], s28 offen sc1
    s_mov_b64 exec, -1
    s_nop 1
p1_go_18:
    s_add_u32 m0, s44, 0
    s_add_u32 s57, s46, 0
    buffer_load_dwordx4 v1, s[4:7], s57 offen offset:0 sc1 lds
    buffer_load_dwordx4 v1, s[4:7], s57 offen offset:1024 sc1 lds
    buffer_load_dwordx4 v1, s[4:7], s57 offen offset:2048 sc1 lds
    buffer_load_dwordx4 v1, s[4:7], s57 offen offset:3072 sc1 lds
    s_add_u32 m0, s44, 4096
    s_add_u32 s57, s46, 4096
    buffer_load_dwordx4 v1, s[4:7], s57 offen offset:0 sc1 lds
    v_mov_b32 v159, v107
    buffer_load_dwordx2 v[96:97], v159, s[4:7], 0 offen offset:0 sc1
    buffer_load_dwordx2 v[98:99], v159, s[4:7], 0 offen offset:128 sc1
    buffer_load_dwordx2 v[100:101], v159, s[4:7], 0 offen offset:256 sc1
    buffer_load_dwordx2 v[102:103], v159, s[4:7], 0 offen offset:384 sc1
    buffer_load_dwordx2 v[140:141], v159, s[4:7], 0 offen offset:512 sc1
    buffer_load_dwordx2 v[142:143], v159, s[4:7], 0 offen offset:640 sc1
    buffer_load_dwordx2 v[144:145], v159, s[4:7], 0 offen offset:768 sc1
    buffer_load_dwordx2 v[146:147], v159, s[4:7], 0 offen offset:896 sc1
    s_add_u32 m0, s44, 20480
    s_add_u32 s57, s46, 5120
    buffer_load_dwordx4 v1, s[4:7], s57 offen offset:0 sc1 lds
    buffer_load_dwordx4 v1, s[4:7], s57 offen offset:1024 sc1 lds
    buffer_load_dwordx4 v1, s[4:7], s57 offen offset:2048 sc1 lds
    buffer_load_dwordx4 v1, s[4:7], s57 offen offset:3072 sc1 lds
    s_add_u32 m0, s44, 24576
    s_add_u32 s57, s46, 9216
    buffer_load_dwordx4 v1, s[4:7], s57 offen offset:0 sc1 lds
    s_cmp_lg_u32 s24, 0
    s_cbranch_scc1 p0_21
    s_add_u32 s58, s62, 8192
    buffer_load_dwordx4 a[140:143], v1, s[4:7], s58 offen offset:2048
    buffer_load_dwordx4 a[144:147], v1, s[4:7], s58 offen offset:3072
    s_add_u32 s58, s62, 12288
    buffer_load_dwordx4 a[148:151], v1, s[4:7], s58 offen offset:0
    buffer_load_dwordx4 a[152:155], v1, s[4:7], s58 offen offset:1024
    buffer_load_dwordx4 a[156:159], v1, s[4:7], s58 offen offset:2048
    buffer_load_dwordx4 a[160:163], v1, s[4:7], s58 offen offset:3072
    s_add_u32 s58, s62, 16384
    buffer_load_dwordx4 a[164:167], v1, s[4:7], s58 offen offset:0
    buffer_load_dwordx4 a[168:171], v1, s[4:7], s58 offen offset:1024
    buffer_load_dwordx4 a[172:175], v1, s[4:7], s58 offen offset:2048
    buffer_load_dwordx4 a[176:179], v1, s[4:7], s58 offen offset:3072
    s_add_u32 s58, s62, 20480
    buffer_load_dwordx4 a[180:183], v1, s[4:7], s58 offen offset:0
    buffer_load_dwordx4 a[184:187], v1, s[4:7], s58 offen offset:1024
    buffer_load_dwordx4 a[188:191], v1, s[4:7], s58 offen offset:2048
    buffer_load_dwordx4 a[192:195], v1, s[4:7], s58 offen offset:3072
    s_add_u32 s58, s62, 24576
    buffer_load_dwordx4 a[196:199], v1, s[4:7], s58 offen offset:0
    s_nop 1
p0_21:
    s_mov_b32 s3, 0x40000000
    buffer_load_dword v163, v63, s[4:7], s3 offen
    s_waitcnt vmcnt(14)
    s_waitcnt lgkmcnt(0)
    s_barrier
    ds_read_b128 v[104:107], v148 offset:0
    ds_read_b128 v[108:111], v148 offset:5120
    ds_read_b128 v[112:115], v148 offset:10240
    ds_read_b128 v[116:119], v148 offset:15360
    ds_read_b128 v[120:123], v148 offset:1024
    ds_read_b128 v[124:127], v148 offset:6144
    s_waitcnt lgkmcnt(4)
    v_mfma_f32_16x16x32_bf16 v[64:67], a[100:103], v[104:107], 0
    ds_read_b128 v[128:131], v148 offset:11264
    s_add_u32 m0, s44, 40960
    v_mfma_f32_16x16x32_bf16 v[68:71], a[104:107], v[104:107], 0
    s_add_u32 s57, s46, 10240
    buffer_load_dwordx4 v1, s[4:7], s57 offen offset:0 sc1 lds
    v_mfma_f32_16x16x32_bf16 v[72:75], a[100:103], v[108:111], 0
    ds_read_b128 v[132:135], v148 offset:16384
    v_mfma_f32_16x16x32_bf16 v[76:79], a[104:107], v[108:111], 0
    s_waitcnt lgkmcnt(4)
    v_mfma_f32_16x16x32_bf16 v[80:83], a[100:103], v[112:115], 0
    ds_read_b128 v[104:107], v148 offset:2048
    s_waitcnt vmcnt(7)
    v_mfma_f32_16x16x32_bf16 v[84:87], a[104:107], v[112:115], 0
    buffer_load_dwordx4 v1, s[4:7], s57 offen offset:1024 sc1 lds
    v_add_f32 v96, v96, v140
    v_mfma_f32_16x16x32_bf16 v[88:91], a[100:103], v[116:119], 0
    ds_read_b128 v[108:111], v148 offset:7168
    v_add_f32 v97, v97, v141
    v_mfma_f32_16x16x32_bf16 v[92:95], a[104:107], v[116:119], 0
    s_waitcnt lgkmcnt(4)
    v_add_f32 v98, v98, v142
    v_add_f32 v99, v99, v143
    v_mfma_f32_16x16x32_bf16 v[64:67], a[108:111], v[120:123], v[64:67]
    ds_read_b128 v[112:115], v148 offset:12288
    v_add_f32 v100, v100, v144
    v_mfma_f32_16x16x32_bf16 v[68:71], a[112:115], v[120:123], v[68:71]
    buffer_load_dwordx4 v1, s[4:7], s57 offen offset:2048 sc1 lds
    v_add_f32 v101, v101, v145
    v_mfma_f32_16x16x32_bf16 v[72:75], a[108:111], v[124:127], v[72:75]
    ds_read_b128 v[116:119], v148 offset:17408
    v_add_f32 v102, v102, v146
    v_mfma_f32_16x16x32_bf16 v[76:79], a[112:115], v[124:127], v[76:79]
    s_waitcnt lgkmcnt(4)
    v_add_f32 v103, v103, v147
    v_add_f32 v96, v96, v100
    v_mfma_f32_16x16x32_bf16 v[80:83], a[108:111], v[128:131], v[80:83]
    ds_read_b128 v[120:123], v148 offset:3072
    v_add_f32 v97, v97, v101
    v_mfma_f32_16x16x32_bf16 v[84:87], a[112:115], v[128:131], v[84:87]
    buffer_load_dwordx4 v1, s[4:7], s57 offen offset:3072 sc1 lds
    v_add_f32 v98, v98, v102
    v_mfma_f32_16x16x32_bf16 v[88:91], a[108:111], v[132:135], v[88:91]
    ds_read_b128 v[124:127], v148 offset:8192
    s_add_u32 m0, s44, 45056
    v_mfma_f32_16x16x32_bf16 v[92:95], a[112:115], v[132:135], v[92:95]
    s_add_u32 s57, s46, 14336
    v_add_f32 v99, v99, v103
    s_waitcnt lgkmcnt(4)
    v_mfma_f32_16x16x32_bf16 v[64:67], a[116:119], v[104:107], v[64:67]
    ds_read_b128 v[128:131], v148 offset:13312
    v_add_f32 v96, v96, v98
    v_mfma_f32_16x16x32_bf16 v[68:71], a[120:123], v[104:107], v[68:71]
    buffer_load_dwordx4 v1, s[4:7], s57 offen offset:0 sc1 lds
    v_add_f32 v97, v97, v99
    v_mfma_f32_16x16x32_bf16 v[72:75], a[116:119], v[108:111], v[72:75]
    ds_read_b128 v[132:135], v148 offset:18432
    s_add_u32 s58, s62, 24576
    v_mfma_f32_16x16x32_bf16 v[76:79], a[120:123], v[108:111], v[76:79]
    s_waitcnt lgkmcnt(4)
    v_mul_f32 v96, s42, v96
    v_mul_f32 v97, s42, v97
    v_mfma_f32_16x16x32_bf16 v[80:83], a[116:119], v[112:115], v[80:83]
    ds_read_b128 v[104:107], v148 offset:4096
    v_fma_f32 v97, v96, v96, v97
    v_mfma_f32_16x16x32_bf16 v[84:87], a[120:123], v[112:115], v[84:87]
    buffer_load_dwordx4 a[200:203], v1, s[4:7], s58 offen offset:1024
    v_min_f32 v97, 0, v97
    v_mfma_f32_16x16x32_bf16 v[88:91], a[116:119], v[116:119], v[88:91]
    ds_read_b128 v[108:111], v148 offset:9216
    v_cvt_pk_bf16_f32 v97, v96, v97
    v_mfma_f32_16x16x32_bf16 v[92:95], a[120:123], v[116:119], v[92:95]
    s_waitcnt lgkmcnt(4)
    v_lshlrev_b32 v96, 16, v97
    v_and_b32 v97, 0xffff0000, v97
    v_mfma_f32_16x16x32_bf16 v[64:67], a[124:127], v[120:123], v[64:67]
    ds_read_b128 v[112:115], v148 offset:14336
    v_sub_f32 v97, s43, v97
    v_mfma_f32_16x16x32_bf16 v[68:71], a[128:131], v[120:123], v[68:71]
    buffer_load_dwordx4 a[204:207], v1, s[4:7], s58 offen offset:2048
    v_cvt_pk_bf16_f32 v97, 0, v97
    v_mfma_f32_16x16x32_bf16 v[72:75], a[124:127], v[124:127], v[72:75]
    ds_read_b128 v[116:119], v148 offset:19456
    v_mfma_f32_16x16x32_bf16 v[76:79], a[128:131], v[124:127], v[76:79]
    s_waitcnt lgkmcnt(4)
    v_sqrt_f32 v97, v97
    s_nop 0
    v_cvt_pk_bf16_f32 v97, 0, v97
    v_rcp_f32 v97, v97
    s_nop 0
    ds_write_b64 v158, v[96:97]
    s_waitcnt lgkmcnt(0)
    s_waitcnt vmcnt(8)
    s_barrier
    v_mfma_f32_16x16x32_bf16 v[80:83], a[124:127], v[128:131], v[80:83]
    ds_read_b128 v[120:123], v148 offset:20480
    v_mfma_f32_16x16x32_bf16 v[84:87], a[128:131], v[128:131], v[84:87]
    buffer_load_dwordx4 a[208:211], v1, s[4:7], s58 offen offset:3072
    v_mfma_f32_16x16x32_bf16 v[88:91], a[124:127], v[132:135], v[88:91]
    ds_read_b128 v[124:127], v148 offset:25600
    s_add_u32 s58, s62, 28672
    v_mfma_f32_16x16x32_bf16 v[92:95], a[128:131], v[132:135], v[92:95]
    v_mfma_f32_16x16x32_bf16 v[64:67], a[132:135], v[104:107], v[64:67]
    ds_read_b128 v[128:131], v148 offset:30720
    v_mfma_f32_16x16x32_bf16 v[68:71], a[136:139], v[104:107], v[68:71]
    buffer_load_dwordx4 a[212:215], v1, s[4:7], s58 offen offset:0
    v_mfma_f32_16x16x32_bf16 v[72:75], a[132:135], v[108:111], v[72:75]
    ds_read_b128 v[132:135], v148 offset:35840
    v_mfma_f32_16x16x32_bf16 v[76:79], a[136:139], v[108:111], v[76:79]
    v_mfma_f32_16x16x32_bf16 v[80:83], a[132:135], v[112:115], v[80:83]
    ds_read_b128 v[104:107], v148 offset:21504
    v_mfma_f32_16x16x32_bf16 v[84:87], a[136:139], v[112:115], v[84:87]
    buffer_load_dwordx4 a[216:219], v1, s[4:7], s58 offen offset:1024
    v_mfma_f32_16x16x32_bf16 v[88:91], a[132:135], v[116:119], v[88:91]
    ds_read_b128 v[108:111], v148 offset:26624
    s_add_u32 m0, s44, 61440
    v_mfma_f32_16x16x32_bf16 v[92:95], a[136:139], v[116:119], v[92:95]
    s_add_u32 s57, s46, 15360
    s_waitcnt lgkmcnt(4)
    s_waitcnt vmcnt(10)
    s_cmp_lg_u32 s24, 0
    s_cbranch_scc1 p0_22
    v_mul_u32_u24 v144, 272, v0
    s_mul_i32 s3, s22, 8704
    s_add_u32 s3, s3, 127488
    v_add_u32 v144, s3, v144
    v_mov_b32 v140, 0
    v_mov_b32 v141, 0
    v_mov_b32 v142, 0
    v_mov_b32 v143, 0
    s_mov_b64 exec, 0xffffffff
    ds_write_b128 v144, v[140:143]
    s_mov_b64 exec, -1
    s_nop 1
p0_22:
    v_mfma_f32_16x16x32_bf16 v[64:67], a[140:143], v[120:123], v[64:67]
    ds_read_b128 v[112:115], v148 offset:31744
    v_mfma_f32_16x16x32_bf16 v[68:71], a[144:147], v[120:123], v[68:71]
    buffer_load_dwordx4 v1, s[4:7], s57 offen offset:0 sc1 lds
    v_mfma_f32_16x16x32_bf16 v[72:75], a[140:143], v[124:127], v[72:75]
    ds_read_b128 v[116:119], v148 offset:36864
    v_mfma_f32_16x16x32_bf16 v[76:79], a[144:147], v[124:127], v[76:79]
    s_waitcnt lgkmcnt(4)
    v_mfma_f32_16x16x32_bf16 v[80:83], a[140:143], v[128:131], v[80:83]
    ds_read_b128 v[120:123], v148 offset:22528
    v_mfma_f32_16x16x32_bf16 v[84:87], a[144:147], v[128:131], v[84:87]
    buffer_load_dwordx4 v1, s[4:7], s57 offen offset:1024 sc1 lds
    v_mfma_f32_16x16x32_bf16 v[88:91], a[140:143], v[132:135], v[88:91]
    ds_read_b128 v[124:127], v148 offset:27648
    v_mfma_f32_16x16x32_bf16 v[92:95], a[144:147], v[132:135], v[92:95]
    s_waitcnt lgkmcnt(4)
    v_mfma_f32_16x16x32_bf16 v[64:67], a[148:151], v[104:107], v[64:67]
    ds_read_b128 v[128:131], v148 offset:32768
    v_mfma_f32_16x16x32_bf16 v[68:71], a[152:155], v[104:107], v[68:71]
    buffer_load_dwordx4 v1, s[4:7], s57 offen offset:2048 sc1 lds
    v_mfma_f32_16x16x32_bf16 v[72:75], a[148:151], v[108:111], v[72:75]
    ds_read_b128 v[132:135], v148 offset:37888
    v_mfma_f32_16x16x32_bf16 v[76:79], a[152:155], v[108:111], v[76:79]
    s_waitcnt lgkmcnt(4)
    v_mfma_f32_16x16x32_bf16 v[80:83], a[148:151], v[112:115], v[80:83]
    ds_read_b128 v[104:107], v148 offset:23552
    v_mfma_f32_16x16x32_bf16 v[84:87], a[152:155], v[112:115], v[84:87]
    buffer_load_dwordx4 v1, s[4:7], s57 offen offset:3072 sc1 lds
    v_mfma_f32_16x16x32_bf16 v[88:91], a[148:151], v[116:119], v[88:91]
    ds_read_b128 v[108:111], v148 offset:28672
    s_add_u32 m0, s44, 65536
    v_mfma_f32_16x16x32_bf16 v[92:95], a[152:155], v[116:119], v[92:95]
    s_add_u32 s57, s46, 19456
    s_waitcnt lgkmcnt(4)
    v_mfma_f32_16x16x32_bf16 v[64:67], a[156:159], v[120:123], v[64:67]
    ds_read_b128 v[112:115], v148 offset:33792
    v_mfma_f32_16x16x32_bf16 v[68:71], a[160:163], v[120:123], v[68:71]
    buffer_load_dwordx4 v1, s[4:7], s57 offen offset:0 sc1 lds
    v_mfma_f32_16x16x32_bf16 v[72:75], a[156:159], v[124:127], v[72:75]
    ds_read_b128 v[116:119], v148 offset:38912
    v_mfma_f32_16x16x32_bf16 v[76:79], a[160:163], v[124:127], v[76:79]
    s_waitcnt lgkmcnt(4)
    v_mfma_f32_16x16x32_bf16 v[80:83], a[156:159], v[128:131], v[80:83]
    ds_read_b128 v[120:123], v148 offset:24576
    v_mfma_f32_16x16x32_bf16 v[84:87], a[160:163], v[128:131], v[84:87]
    buffer_load_dwordx4 a[220:223], v1, s[4:7], s58 offen offset:2048
    v_mfma_f32_16x16x32_bf16 v[88:91], a[156:159], v[132:135], v[88:91]
    ds_read_b128 v[124:127], v148 offset:29696
    v_mfma_f32_16x16x32_bf16 v[92:95], a[160:163], v[132:135], v[92:95]
    s_waitcnt lgkmcnt(4)
    v_mfma_f32_16x16x32_bf16 v[64:67], a[164:167], v[104:107], v[64:67]
    ds_read_b128 v[128:131], v148 offset:34816
    v_mfma_f32_16x16x32_bf16 v[68:71], a[168:171], v[104:107], v[68:71]
    buffer_load_dwordx4 a[224:227], v1, s[4:7], s58 offen offset:3072
    v_mfma_f32_16x16x32_bf16 v[72:75], a[164:167], v[108:111], v[72:75]
    ds_read_b128 v[132:135], v148 offset:39936
    s_add_u32 s58, s62, 32768
    v_mfma_f32_16x16x32_bf16 v[76:79], a[168:171], v[108:111], v[76:79]
    s_waitcnt lgkmcnt(4)
    s_waitcnt vmcnt(12)
    s_barrier
    v_mfma_f32_16x16x32_bf16 v[80:83], a[164:167], v[112:115], v[80:83]
    ds_read_b128 v[104:107], v148 offset:40960
    v_mfma_f32_16x16x32_bf16 v[84:87], a[168:171], v[112:115], v[84:87]
    buffer_load_dwordx4 a[228:231], v1, s[4:7], s58 offen offset:0
    v_mfma_f32_16x16x32_bf16 v[88:91], a[164:167], v[116:119], v[88:91]
    ds_read_b128 v[108:111], v148 offset:46080
    v_mfma_f32_16x16x32_bf16 v[92:95], a[168:171], v[116:119], v[92:95]
    s_waitcnt lgkmcnt(4)
    v_mfma_f32_16x16x32_bf16 v[64:67], a[172:175], v[120:123], v[64:67]
    ds_read_b128 v[112:115], v148 offset:51200
    v_mfma_f32_16x16x32_bf16 v[68:71], a[176:179], v[120:123], v[68:71]
    buffer_load_dwordx4 a[232:235], v1, s[4:7], s58 offen offset:1024
    v_mfma_f32_16x16x32_bf16 v[72:75], a[172:175], v[124:127], v[72:75]
    ds_read_b128 v[116:119], v148 offset:56320
    v_mfma_f32_16x16x32_bf16 v[76:79], a[176:179], v[124:127], v[76:79]
    s_waitcnt lgkmcnt(4)
    v_mfma_f32_16x16x32_bf16 v[80:83], a[172:175], v[128:131], v[80:83]
    ds_read_b128 v[120:123], v148 offset:41984
    v_mfma_f32_16x16x32_bf16 v[84:87], a[176:179], v[128:131], v[84:87]
    buffer_load_dwordx4 a[236:239], v1, s[4:7], s58 offen offset:2048
    v_mfma_f32_16x16x32_bf16 v[88:91], a[172:175], v[132:135], v[88:91]
    ds_read_b128 v[124:127], v148 offset:47104
    v_mfma_f32_16x16x32_bf16 v[92:95], a[176:179], v[132:135], v[92:95]
    s_waitcnt lgkmcnt(4)
    s_waitcnt vmcnt(10)
    v_mfma_f32_16x16x32_bf16 v[64:67], a[180:183], v[104:107], v[64:67]
    ds_read_b128 v[128:131], v148 offset:52224
    v_mfma_f32_16x16x32_bf16 v[68:71], a[184:187], v[104:107], v[68:71]
    buffer_load_dwordx4 a[240:243], v1, s[4:7], s58 offen offset:3072
    v_mfma_f32_16x16x32_bf16 v[72:75], a[180:183], v[108:111], v[72:75]
    ds_read_b128 v[132:135], v148 offset:57344
    s_add_u32 s58, s62, 36864
    v_mfma_f32_16x16x32_bf16 v[76:79], a[184:187], v[108:111], v[76:79]
    s_waitcnt lgkmcnt(4)
    v_mfma_f32_16x16x32_bf16 v[80:83], a[180:183], v[112:115], v[80:83]
    ds_read_b128 v[104:107], v148 offset:43008
    v_mfma_f32_16x16x32_bf16 v[84:87], a[184:187], v[112:115], v[84:87]
    buffer_load_dwordx4 a[244:247], v1, s[4:7], s58 offen offset:0
    v_mfma_f32_16x16x32_bf16 v[88:91], a[180:183], v[116:119], v[88:91]
    ds_read_b128 v[108:111], v148 offset:48128
    v_mfma_f32_16x16x32_bf16 v[92:95], a[184:187], v[116:119], v[92:95]
    s_waitcnt lgkmcnt(4)
    v_mfma_f32_16x16x32_bf16 v[64:67], a[188:191], v[120:123], v[64:67]
    ds_read_b128 v[112:115], v148 offset:53248
    v_mfma_f32_16x16x32_bf16 v[68:71], a[192:195], v[120:123], v[68:71]
    buffer_load_dwordx4 a[248:251], v1, s[4:7], s58 offen offset:1024
    v_mfma_f32_16x16x32_bf16 v[72:75], a[188:191], v[124:127], v[72:75]
    ds_read_b128 v[116:119], v148 offset:58368
    v_mfma_f32_16x16x32_bf16 v[76:79], a[192:195], v[124:127], v[76:79]
    s_waitcnt lgkmcnt(4)
    v_mfma_f32_16x16x32_bf16 v[80:83], a[188:191], v[128:131], v[80:83]
    ds_read_b128 v[120:123], v148 offset:44032
    v_mfma_f32_16x16x32_bf16 v[84:87], a[192:195], v[128:131], v[84:87]
    buffer_load_dwordx4 a[252:255], v1, s[4:7], s58 offen offset:2048
    v_mfma_f32_16x16x32_bf16 v[88:91], a[188:191], v[132:135], v[88:91]
    ds_read_b128 v[124:127], v148 offset:49152
    v_mfma_f32_16x16x32_bf16 v[92:95], a[192:195], v[132:135], v[92:95]
    s_waitcnt lgkmcnt(4)
    v_mfma_f32_16x16x32_bf16 v[64:67], a[196:199], v[104:107], v[64:67]
    ds_read_b128 v[128:131], v148 offset:54272
    v_mfma_f32_16x16x32_bf16 v[68:71], a[200:203], v[104:107], v[68:71]
    buffer_load_dwordx4 v[164:167], v1, s[4:7], s58 offen offset:3072
    v_mfma_f32_16x16x32_bf16 v[72:75], a[196:199], v[108:111], v[72:75]
    ds_read_b128 v[132:135], v148 offset:59392
    s_add_u32 m0, s44, 81920
    v_mfma_f32_16x16x32_bf16 v[76:79], a[200:203], v[108:111], v[76:79]
    s_add_u32 s57, s45, 7925760
    s_waitcnt lgkmcnt(4)
    v_mfma_f32_16x16x32_bf16 v[80:83], a[196:199], v[112:115], v[80:83]
    ds_read_b128 v[104:107], v148 offset:45056
    v_mfma_f32_16x16x32_bf16 v[84:87], a[200:203], v[112:115], v[84:87]
    buffer_load_dwordx4 v1, s[4:7], s57 offen offset:0 sc1 lds
    v_mfma_f32_16x16x32_bf16 v[88:91], a[196:199], v[116:119], v[88:91]
    ds_read_b128 v[108:111], v148 offset:50176
    v_mfma_f32_16x16x32_bf16 v[92:95], a[200:203], v[116:119], v[92:95]
    s_waitcnt lgkmcnt(4)
    v_mfma_f32_16x16x32_bf16 v[64:67], a[204:207], v[120:123], v[64:67]
    ds_read_b128 v[112:115], v148 offset:55296
    v_mfma_f32_16x16x32_bf16 v[68:71], a[208:211], v[120:123], v[68:71]
    buffer_load_dwordx4 v1, s[4:7], s57 offen offset:1024 sc1 lds
    v_mfma_f32_16x16x32_bf16 v[72:75], a[204:207], v[124:127], v[72:75]
    ds_read_b128 v[116:119], v148 offset:60416
    v_mfma_f32_16x16x32_bf16 v[76:79], a[208:211], v[124:127], v[76:79]
    s_waitcnt lgkmcnt(4)
    s_waitcnt vmcnt(12)
    s_barrier
    v_mfma_f32_16x16x32_bf16 v[80:83], a[204:207], v[128:131], v[80:83]
    ds_read_b128 v[120:123], v149 offset:0
    v_mfma_f32_16x16x32_bf16 v[84:87], a[208:211], v[128:131], v[84:87]
    buffer_load_dwordx4 v1, s[4:7], s57 offen offset:2048 sc1 lds
    v_mfma_f32_16x16x32_bf16 v[88:91], a[204:207], v[132:135], v[88:91]
    ds_read_b128 v[124:127], v149 offset:5120
    v_mfma_f32_16x16x32_bf16 v[92:95], a[208:211], v[132:135], v[92:95]
    s_waitcnt lgkmcnt(4)
    v_mfma_f32_16x16x32_bf16 v[64:67], a[212:215], v[104:107], v[64:67]
    ds_read_b128 v[128:131], v149 offset:10240
    v_mfma_f32_16x16x32_bf16 v[68:71], a[216:219], v[104:107], v[68:71]
    buffer_load_dwordx4 v1, s[4:7], s57 offen offset:3072 sc1 lds
    v_mfma_f32_16x16x32_bf16 v[72:75], a[212:215], v[108:111], v[72:75]
    ds_read_b128 v[132:135], v149 offset:15360
    s_add_u32 m0, s44, 86016
    v_mfma_f32_16x16x32_bf16 v[76:79], a[216:219], v[108:111], v[76:79]
    s_add_u32 s57, s45, 7929856
    s_waitcnt lgkmcnt(4)
    v_mfma_f32_16x16x32_bf16 v[80:83], a[212:215], v[112:115], v[80:83]
    ds_read_b128 v[104:107], v149 offset:1024
    v_mfma_f32_16x16x32_bf16 v[84:87], a[216:219], v[112:115], v[84:87]
    buffer_load_dwordx4 v1, s[4:7], s57 offen offset:0 sc1 lds
    v_mfma_f32_16x16x32_bf16 v[88:91], a[212:215], v[116:119], v[88:91]
    ds_read_b128 v[108:111], v149 offset:6144
    s_add_u32 m0, s44, 102400
    v_mfma_f32_16x16x32_bf16 v[92:95], a[216:219], v[116:119], v[92:95]
    s_add_u32 s57, s45, 7946240
    s_waitcnt lgkmcnt(4)
    s_waitcnt vmcnt(5)
    v_mfma_f32_16x16x32_bf16 v[64:67], a[220:223], v[120:123], v[64:67]
    ds_read_b128 v[112:115], v149 offset:11264
    v_mfma_f32_16x16x32_bf16 v[68:71], a[224:227], v[120:123], v[68:71]
    buffer_load_dwordx4 v1, s[4:7], s57 offen offset:0 sc1 lds
    v_mfma_f32_16x16x32_bf16 v[72:75], a[220:223], v[124:127], v[72:75]
    ds_read_b128 v[116:119], v149 offset:16384
    v_mfma_f32_16x16x32_bf16 v[76:79], a[224:227], v[124:127], v[76:79]
    s_waitcnt lgkmcnt(4)
    v_mfma_f32_16x16x32_bf16 v[80:83], a[220:223], v[128:131], v[80:83]
    ds_read_b128 v[120:123], v149 offset:2048
    v_mfma_f32_16x16x32_bf16 v[84:87], a[224:227], v[128:131], v[84:87]
    buffer_load_dwordx4 v1, s[4:7], s57 offen offset:1024 sc1 lds
    v_mfma_f32_16x16x32_bf16 v[88:91], a[220:223], v[132:135], v[88:91]
    ds_read_b128 v[124:127], v149 offset:7168
    v_mfma_f32_16x16x32_bf16 v[92:95], a[224:227], v[132:135], v[92:95]
    s_waitcnt lgkmcnt(4)
    v_mfma_f32_16x16x32_bf16 v[64:67], a[228:231], v[104:107], v[64:67]
    ds_read_b128 v[128:131], v149 offset:12288
    v_mfma_f32_16x16x32_bf16 v[68:71], a[232:235], v[104:107], v[68:71]
    buffer_load_dwordx4 v1, s[4:7], s57 offen offset:2048 sc1 lds
    v_mfma_f32_16x16x32_bf16 v[72:75], a[228:231], v[108:111], v[72:75]
    ds_read_b128 v[132:135], v149 offset:17408
    v_mfma_f32_16x16x32_bf16 v[76:79], a[232:235], v[108:111], v[76:79]
    s_waitcnt lgkmcnt(4)
    v_mfma_f32_16x16x32_bf16 v[80:83], a[228:231], v[112:115], v[80:83]
    ds_read_b128 v[104:107], v149 offset:3072
    v_mfma_f32_16x16x32_bf16 v[84:87], a[232:235], v[112:115], v[84:87]
    buffer_load_dwordx4 v1, s[4:7], s57 offen offset:3072 sc1 lds
    v_mfma_f32_16x16x32_bf16 v[88:91], a[228:231], v[116:119], v[88:91]
    ds_read_b128 v[108:111], v149 offset:8192
    s_add_u32 m0, s44, 106496
    v_mfma_f32_16x16x32_bf16 v[92:95], a[232:235], v[116:119], v[92:95]
    s_add_u32 s57, s45, 7950336
    s_waitcnt lgkmcnt(4)
    s_mul_i32 s36, s22, 1280
    s_add_u32 s36, s36, 38291456
    s_cmp_eq_u32 s24, 0
    s_cselect_b32 s36, s36, 1073741824
    buffer_load_dwordx4 v[96:99], v1, s[4:7], s36 offen sc1
    buffer_load_dwordx4 v[100:103], v1, s[4:7], s36 offen offset:256 sc1
    v_mfma_f32_16x16x32_bf16 v[64:67], a[236:239], v[120:123], v[64:67]
    ds_read_b128 v[112:115], v149 offset:13312
    v_mfma_f32_16x16x32_bf16 v[68:71], a[240:243], v[120:123], v[68:71]
    buffer_load_dwordx4 v1, s[4:7], s57 offen offset:0 sc1 lds
    v_mfma_f32_16x16x32_bf16 v[72:75], a[236:239], v[124:127], v[72:75]
    ds_read_b128 v[116:119], v149 offset:18432
    s_add_u32 m0, s44, 0
    v_mfma_f32_16x16x32_bf16 v[76:79], a[240:243], v[124:127], v[76:79]
    s_add_u32 s57, s45, 7966720
    s_waitcnt lgkmcnt(4)
    v_mfma_f32_16x16x32_bf16 v[80:83], a[236:239], v[128:131], v[80:83]
    ds_read_b128 v[120:123], v149 offset:4096
    v_mfma_f32_16x16x32_bf16 v[84:87], a[240:243], v[128:131], v[84:87]
    buffer_load_dwordx4 v1, s[4:7], s57 offen offset:0 sc1 lds
    v_mfma_f32_16x16x32_bf16 v[88:91], a[236:239], v[132:135], v[88:91]
    ds_read_b128 v[124:127], v149 offset:9216
    v_mfma_f32_16x16x32_bf16 v[92:95], a[240:243], v[132:135], v[92:95]
    s_waitcnt lgkmcnt(4)
    v_mfma_f32_16x16x32_bf16 v[64:67], a[244:247], v[104:107], v[64:67]
    ds_read_b128 v[128:131], v149 offset:14336
    v_mfma_f32_16x16x32_bf16 v[68:71], a[248:251], v[104:107], v[68:71]
    buffer_load_dwordx4 v1, s[4:7], s57 offen offset:1024 sc1 lds
    v_mfma_f32_16x16x32_bf16 v[72:75], a[244:247], v[108:111], v[72:75]
    ds_read_b128 v[132:135], v149 offset:19456
    v_mfma_f32_16x16x32_bf16 v[76:79], a[248:251], v[108:111], v[76:79]
    s_waitcnt lgkmcnt(4)
    s_waitcnt vmcnt(9)
    s_barrier
    v_mfma_f32_16x16x32_bf16 v[80:83], a[244:247], v[112:115], v[80:83]
    ds_read_b128 v[104:107], v149 offset:20480
    v_mfma_f32_16x16x32_bf16 v[84:87], a[248:251], v[112:115], v[84:87]
    buffer_load_dwordx4 v1, s[4:7], s57 offen offset:2048 sc1 lds
    v_mfma_f32_16x16x32_bf16 v[88:91], a[244:247], v[116:119], v[88:91]
    ds_read_b128 v[108:111], v149 offset:21504
    v_mfma_f32_16x16x32_bf16 v[92:95], a[248:251], v[116:119], v[92:95]
    s_waitcnt lgkmcnt(4)
    v_mfma_f32_16x16x32_bf16 v[64:67], a[252:255], v[120:123], v[64:67]
    ds_read_b128 v[112:115], v149 offset:22528
    v_mfma_f32_16x16x32_bf16 v[68:71], v[164:167], v[120:123], v[68:71]
    buffer_load_dwordx4 v1, s[4:7], s57 offen offset:3072 sc1 lds
    v_mfma_f32_16x16x32_bf16 v[72:75], a[252:255], v[124:127], v[72:75]
    ds_read_b128 v[116:119], v149 offset:23552
    s_add_u32 m0, s44, 4096
    v_mfma_f32_16x16x32_bf16 v[76:79], v[164:167], v[124:127], v[76:79]
    s_add_u32 s57, s45, 7970816
    s_waitcnt lgkmcnt(4)
    v_mfma_f32_16x16x32_bf16 v[80:83], a[252:255], v[128:131], v[80:83]
    ds_read_b128 v[120:123], v149 offset:24576
    v_mfma_f32_16x16x32_bf16 v[84:87], v[164:167], v[128:131], v[84:87]
    buffer_load_dwordx4 v1, s[4:7], s57 offen offset:0 sc1 lds
    v_mfma_f32_16x16x32_bf16 v[88:91], a[252:255], v[132:135], v[88:91]
    ds_read_b128 v[124:127], v149 offset:25600
    s_add_u32 m0, s44, 20480
    v_mfma_f32_16x16x32_bf16 v[92:95], v[164:167], v[132:135], v[92:95]
    s_add_u32 s57, s45, 7987200
    s_waitcnt lgkmcnt(4)
    s_waitcnt vmcnt(6)
    s_cmp_lg_u32 s24, 0
    s_cbranch_scc1 p0_23
    s_mov_b32 s3, 0
    s_nop 1
ls_24:
    s_mov_b64 s[50:51], 0
    v_cmp_ne_u64 vcc, s[100:101], v[96:97]
    s_nop 0
    s_or_b64 s[50:51], s[50:51], vcc
    v_cmp_ne_u64 vcc, s[100:101], v[98:99]
    s_nop 0
    s_or_b64 s[50:51], s[50:51], vcc
    v_cmp_ne_u64 vcc, s[100:101], v[100:101]
    s_nop 0
    s_or_b64 s[50:51], s[50:51], vcc
    v_cmp_ne_u64 vcc, s[100:101], v[102:103]
    s_nop 0
    s_or_b64 s[50:51], s[50:51], vcc
    s_cmp_eq_u64 s[50:51], 0
    s_cbranch_scc1 lsd_25
    s_add_u32 s3, s3, 1
    s_cmp_gt_u32 s3, 100000
    s_cbranch_scc1 lsd_25
    s_sleep 4
    buffer_load_dwordx4 v[96:99], v1, s[4:7], s36 offen sc1
    buffer_load_dwordx4 v[100:103], v1, s[4:7], s36 offen offset:256 sc1
    s_waitcnt vmcnt(0)
    s_branch ls_24
    s_nop 0
lsd_25:
p0_23:
    s_cmp_lg_u32 s24, 0
    s_cbranch_scc1 p0_26
    v_mov_b32 v136, 0x3f803f80
    v_mov_b32 v137, 0x3f803f80
    v_mov_b32 v138, 0x3f803f80
    v_mov_b32 v139, 0x3f803f80
    s_nop 1
    v_mfma_f32_16x16x32_bf16 v[140:143], a[100:103], v[136:139], 0
    v_mfma_f32_16x16x32_bf16 v[144:147], a[104:107], v[136:139], 0
    v_mfma_f32_16x16x32_bf16 v[140:143], a[108:111], v[136:139], v[140:143]
    v_mfma_f32_16x16x32_bf16 v[144:147], a[112:115], v[136:139], v[144:147]
    v_mfma_f32_16x16x32_bf16 v[140:143], a[116:119], v[136:139], v[140:143]
    v_mfma_f32_16x16x32_bf16 v[144:147], a[120:123], v[136:139], v[144:147]
    v_mfma_f32_16x16x32_bf16 v[140:143], a[124:127], v[136:139], v[140:143]
    v_mfma_f32_16x16x32_bf16 v[144:147], a[128:131], v[136:139], v[144:147]
    v_mfma_f32_16x16x32_bf16 v[140:143], a[132:135], v[136:139], v[140:143]
    v_mfma_f32_16x16x32_bf16 v[144:147], a[136:139], v[136:139], v[144:147]
    v_mfma_f32_16x16x32_bf16 v[140:143], a[140:143], v[136:139], v[140:143]
    v_mfma_f32_16x16x32_bf16 v[144:147], a[144:147], v[136:139], v[144:147]
    v_mfma_f32_16x16x32_bf16 v[140:143], a[148:151], v[136:139], v[140:143]
    v_mfma_f32_16x16x32_bf16 v[144:147], a[152:155], v[136:139], v[144:147]
    v_mfma_f32_16x16x32_bf16 v[140:143], a[156:159], v[136:139], v[140:143]
    v_mfma_f32_16x16x32_bf16 v[144:147], a[160:163], v[136:139], v[144:147]
    v_mfma_f32_16x16x32_bf16 v[140:143], a[164:167], v[136:139], v[140:143]
    v_mfma_f32_16x16x32_bf16 v[144:147], a[168:171], v[136:139], v[144:147]
    v_mfma_f32_16x16x32_bf16 v[140:143], a[172:175], v[136:139], v[140:143]
    v_mfma_f32_16x16x32_bf16 v[144:147], a[176:179], v[136:139], v[144:147]
    v_mfma_f32_16x16x32_bf16 v[140:143], a[180:183], v[136:139], v[140:143]
    v_mfma_f32_16x16x32_bf16 v[144:147], a[184:187], v[136:139], v[144:147]
    v_mfma_f32_16x16x32_bf16 v[140:143], a[188:191], v[136:139], v[140:143]
    v_mfma_f32_16x16x32_bf16 v[144:147], a[192:195], v[136:139], v[144:147]
    v_mfma_f32_16x16x32_bf16 v[140:143], a[196:199], v[136:139], v[140:143]
    v_mfma_f32_16x16x32_bf16 v[144:147], a[200:203], v[136:139], v[144:147]
    v_mfma_f32_16x16x32_bf16 v[140:143], a[204:207], v[136:139], v[140:143]
    v_mfma_f32_16x16x32_bf16 v[144:147], a[208:211], v[136:139], v[144:147]
    v_mfma_f32_16x16x32_bf16 v[140:143], a[212:215], v[136:139], v[140:143]
    v_mfma_f32_16x16x32_bf16 v[144:147], a[216:219], v[136:139], v[144:147]
    v_mfma_f32_16x16x32_bf16 v[140:143], a[220:223], v[136:139], v[140:143]
    v_mfma_f32_16x16x32_bf16 v[144:147], a[224:227], v[136:139], v[144:147]
    v_mfma_f32_16x16x32_bf16 v[140:143], a[228:231], v[136:139], v[140:143]
    v_mfma_f32_16x16x32_bf16 v[144:147], a[232:235], v[136:139], v[144:147]
    v_mfma_f32_16x16x32_bf16 v[140:143], a[236:239], v[136:139], v[140:143]
    v_mfma_f32_16x16x32_bf16 v[144:147], a[240:243], v[136:139], v[144:147]
    v_mfma_f32_16x16x32_bf16 v[140:143], a[244:247], v[136:139], v[140:143]
    v_mfma_f32_16x16x32_bf16 v[144:147], a[248:251], v[136:139], v[144:147]
    v_mfma_f32_16x16x32_bf16 v[140:143], a[252:255], v[136:139], v[140:143]
    v_mfma_f32_16x16x32_bf16 v[144:147], v[164:167], v[136:139], v[144:147]
    s_nop 6
    v_mov_b32 v2, v140
    v_mov_b32 v3, v141
    v_mov_b32 v4, v142
    v_mov_b32 v5, v143
    v_mov_b32 v6, v144
    v_mov_b32 v7, v145
    v_mov_b32 v8, v146
    v_mov_b32 v9, v147
    s_nop 4
p0_26:
    ds_read_b64 v[136:137], v151 offset:0
    ds_read_b64 v[138:139], v151 offset:128
    v_mfma_f32_16x16x32_bf16 v[96:99], a[100:103], v[104:107], 0
    ds_read_b128 v[128:131], v149 offset:26624
    v_mfma_f32_16x16x32_bf16 v[100:103], a[104:107], v[104:107], 0
    buffer_load_dwordx4 v1, s[4:7], s57 offen offset:0 sc1 lds
    v_mfma_f32_16x16x32_bf16 v[96:99], a[108:111], v[108:111], v[96:99]
    ds_read_b128 v[132:135], v149 offset:27648
    v_mfma_f32_16x16x32_bf16 v[100:103], a[112:115], v[108:111], v[100:103]
    s_waitcnt lgkmcnt(6)
    v_mfma_f32_16x16x32_bf16 v[96:99], a[116:119], v[112:115], v[96:99]
    ds_read_b128 v[104:107], v149 offset:28672
    v_mfma_f32_16x16x32_bf16 v[100:103], a[120:123], v[112:115], v[100:103]
    buffer_load_dwordx4 v1, s[4:7], s57 offen offset:1024 sc1 lds
    v_mfma_f32_16x16x32_bf16 v[96:99], a[124:127], v[116:119], v[96:99]
    ds_read_b128 v[108:111], v149 offset:29696
    v_mfma_f32_16x16x32_bf16 v[100:103], a[128:131], v[116:119], v[100:103]
    s_waitcnt lgkmcnt(6)
    v_mfma_f32_16x16x32_bf16 v[96:99], a[132:135], v[120:123], v[96:99]
    ds_read_b128 v[112:115], v149 offset:30720
    s_waitcnt lgkmcnt(6)
    v_mfma_f32_16x16x32_bf16 v[100:103], a[136:139], v[120:123], v[100:103]
    buffer_load_dwordx4 v1, s[4:7], s57 offen offset:2048 sc1 lds
    v_fmac_f32 v64, v136, v2
    v_mfma_f32_16x16x32_bf16 v[96:99], a[140:143], v[124:127], v[96:99]
    ds_read_b128 v[116:119], v149 offset:31744
    v_fmac_f32 v65, v136, v3
    v_mfma_f32_16x16x32_bf16 v[100:103], a[144:147], v[124:127], v[100:103]
    s_waitcnt lgkmcnt(4)
    v_fmac_f32 v66, v136, v4
    v_fmac_f32 v67, v136, v5
    v_mfma_f32_16x16x32_bf16 v[96:99], a[148:151], v[128:131], v[96:99]
    ds_read_b128 v[120:123], v149 offset:32768
    v_fmac_f32 v68, v136, v6
    v_mfma_f32_16x16x32_bf16 v[100:103], a[152:155], v[128:131], v[100:103]
    buffer_load_dwordx4 v1, s[4:7], s57 offen offset:3072 sc1 lds
    v_fmac_f32 v69, v136, v7
    v_mfma_f32_16x16x32_bf16 v[96:99], a[156:159], v[132:135], v[96:99]
    ds_read_b128 v[124:127], v149 offset:33792
    s_add_u32 m0, s44, 24576
    v_mfma_f32_16x16x32_bf16 v[100:103], a[160:163], v[132:135], v[100:103]
    s_add_u32 s57, s45, 7991296
    v_fmac_f32 v70, v136, v8
    s_waitcnt lgkmcnt(4)
    v_mfma_f32_16x16x32_bf16 v[96:99], a[164:167], v[104:107], v[96:99]
    ds_read_b128 v[128:131], v149 offset:34816
    v_fmac_f32 v71, v136, v9
    v_mfma_f32_16x16x32_bf16 v[100:103], a[168:171], v[104:107], v[100:103]
    buffer_load_dwordx4 v1, s[4:7], s57 offen offset:0 sc1 lds
    v_mul_f32 v64, v64, v137
    v_mfma_f32_16x16x32_bf16 v[96:99], a[172:175], v[108:111], v[96:99]
    ds_read_b128 v[132:135], v149 offset:35840
    v_mul_f32 v65, v65, v137
    v_mfma_f32_16x16x32_bf16 v[100:103], a[176:179], v[108:111], v[100:103]
    s_waitcnt lgkmcnt(4)
    v_mul_f32 v66, v66, v137
    v_mul_f32 v67, v67, v137
    v_mfma_f32_16x16x32_bf16 v[96:99], a[180:183], v[112:115], v[96:99]
    ds_read_b128 v[104:107], v149 offset:36864
    v_mul_f32 v68, v68, v137
    v_mfma_f32_16x16x32_bf16 v[100:103], a[184:187], v[112:115], v[100:103]
    v_mul_f32 v69, v69, v137
    v_mul_f32 v70, v70, v137
    v_mfma_f32_16x16x32_bf16 v[96:99], a[188:191], v[116:119], v[96:99]
    ds_read_b128 v[108:111], v149 offset:37888
    v_mul_f32 v71, v71, v137
    v_mfma_f32_16x16x32_bf16 v[100:103], a[192:195], v[116:119], v[100:103]
    ds_read_b64 v[136:137], v151 offset:256
    s_waitcnt lgkmcnt(5)
    v_mfma_f32_16x16x32_bf16 v[96:99], a[196:199], v[120:123], v[96:99]
    ds_read_b128 v[112:115], v149 offset:38912
    v_cvt_pk_bf16_f32 v140, v64, v65
    v_mfma_f32_16x16x32_bf16 v[100:103], a[200:203], v[120:123], v[100:103]
    v_cvt_pk_bf16_f32 v141, v66, v67
    v_cvt_pk_bf16_f32 v142, v68, v69
    v_mfma_f32_16x16x32_bf16 v[96:99], a[204:207], v[124:127], v[96:99]
    ds_read_b128 v[116:119], v149 offset:39936
    v_cvt_pk_bf16_f32 v143, v70, v71
    v_mfma_f32_16x16x32_bf16 v[100:103], a[208:211], v[124:127], v[100:103]
    s_waitcnt lgkmcnt(5)
    s_waitcnt vmcnt(10)
    s_barrier
    v_mfma_f32_16x16x32_bf16 v[96:99], a[212:215], v[128:131], v[96:99]
    ds_read_b128 v[120:123], v149 offset:40960
    s_add_u32 m0, s44, 40960
    v_mfma_f32_16x16x32_bf16 v[100:103], a[216:219], v[128:131], v[100:103]
    s_add_u32 s57, s45, 8007680
    buffer_load_dwordx4 v1, s[4:7], s57 offen offset:0 sc1 lds
    v_mfma_f32_16x16x32_bf16 v[96:99], a[220:223], v[132:135], v[96:99]
    ds_read_b128 v[124:127], v149 offset:41984
    v_mfma_f32_16x16x32_bf16 v[100:103], a[224:227], v[132:135], v[100:103]
    s_waitcnt lgkmcnt(5)
    v_mfma_f32_16x16x32_bf16 v[96:99], a[228:231], v[104:107], v[96:99]
    ds_read_b128 v[128:131], v149 offset:43008
    v_mfma_f32_16x16x32_bf16 v[100:103], a[232:235], v[104:107], v[100:103]
    buffer_load_dwordx4 v1, s[4:7], s57 offen offset:1024 sc1 lds
    v_mfma_f32_16x16x32_bf16 v[96:99], a[236:239], v[108:111], v[96:99]
    ds_read_b128 v[132:135], v149 offset:44032
    v_mfma_f32_16x16x32_bf16 v[100:103], a[240:243], v[108:111], v[100:103]
    s_waitcnt lgkmcnt(4)
    v_mfma_f32_16x16x32_bf16 v[96:99], a[244:247], v[112:115], v[96:99]
    ds_read_b128 v[104:107], v149 offset:45056
    v_mfma_f32_16x16x32_bf16 v[100:103], a[248:251], v[112:115], v[100:103]
    buffer_load_dwordx4 v1, s[4:7], s57 offen offset:2048 sc1 lds
    v_mfma_f32_16x16x32_bf16 v[96:99], a[252:255], v[116:119], v[96:99]
    ds_read_b128 v[108:111], v149 offset:46080
    v_mfma_f32_16x16x32_bf16 v[100:103], v[164:167], v[116:119], v[100:103]
    s_waitcnt lgkmcnt(4)
    ds_write_b128 v150, v[140:143] offset:0
    v_mfma_f32_16x16x32_bf16 v[64:67], a[100:103], v[120:123], 0
    ds_read_b128 v[112:115], v149 offset:47104
    v_mfma_f32_16x16x32_bf16 v[68:71], a[104:107], v[120:123], 0
    buffer_load_dwordx4 v1, s[4:7], s57 offen offset:3072 sc1 lds
    v_fmac_f32 v72, v138, v2
    v_mfma_f32_16x16x32_bf16 v[64:67], a[108:111], v[124:127], v[64:67]
    ds_read_b128 v[116:119], v149 offset:48128
    s_add_u32 m0, s44, 45056
    v_mfma_f32_16x16x32_bf16 v[68:71], a[112:115], v[124:127], v[68:71]
    s_add_u32 s57, s45, 8011776
    v_fmac_f32 v73, v138, v3
    s_waitcnt lgkmcnt(5)
    v_mfma_f32_16x16x32_bf16 v[64:67], a[116:119], v[128:131], v[64:67]
    ds_read_b128 v[120:123], v149 offset:49152
    v_fmac_f32 v74, v138, v4
    v_mfma_f32_16x16x32_bf16 v[68:71], a[120:123], v[128:131], v[68:71]
    buffer_load_dwordx4 v1, s[4:7], s57 offen offset:0 sc1 lds
    v_fmac_f32 v75, v138, v5
    v_mfma_f32_16x16x32_bf16 v[64:67], a[124:127], v[132:135], v[64:67]
    ds_read_b128 v[124:127], v149 offset:50176
    s_add_u32 s58, s63, 0
    v_mfma_f32_16x16x32_bf16 v[68:71], a[128:131], v[132:135], v[68:71]
    s_waitcnt lgkmcnt(5)
    v_fmac_f32 v76, v138, v6
    v_fmac_f32 v77, v138, v7
    v_mfma_f32_16x16x32_bf16 v[64:67], a[132:135], v[104:107], v[64:67]
    ds_read_b128 v[128:131], v149 offset:51200
    v_fmac_f32 v78, v138, v8
    v_mfma_f32_16x16x32_bf16 v[68:71], a[136:139], v[104:107], v[68:71]
    buffer_load_dwordx4 a[0:3], v1, s[4:7], s58 offen offset:0
    v_fmac_f32 v79, v138, v9
    v_mfma_f32_16x16x32_bf16 v[64:67], a[140:143], v[108:111], v[64:67]
    ds_read_b128 v[132:135], v149 offset:52224
    v_mul_f32 v72, v72, v139
    v_mfma_f32_16x16x32_bf16 v[68:71], a[144:147], v[108:111], v[68:71]
    s_waitcnt lgkmcnt(4)
    v_mul_f32 v73, v73, v139
    v_mul_f32 v74, v74, v139
    v_mfma_f32_16x16x32_bf16 v[64:67], a[148:151], v[112:115], v[64:67]
    ds_read_b128 v[104:107], v149 offset:53248
    v_mul_f32 v75, v75, v139
    v_mfma_f32_16x16x32_bf16 v[68:71], a[152:155], v[112:115], v[68:71]
    buffer_load_dwordx4 a[4:7], v1, s[4:7], s58 offen offset:1024
    v_mul_f32 v76, v76, v139
    v_mfma_f32_16x16x32_bf16 v[64:67], a[156:159], v[116:119], v[64:67]
    ds_read_b128 v[108:111], v149 offset:54272
    v_mul_f32 v77, v77, v139
    v_mfma_f32_16x16x32_bf16 v[68:71], a[160:163], v[116:119], v[68:71]
    s_waitcnt lgkmcnt(4)
    v_mul_f32 v78, v78, v139
    v_mul_f32 v79, v79, v139
    v_mfma_f32_16x16x32_bf16 v[64:67], a[164:167], v[120:123], v[64:67]
    ds_read_b128 v[112:115], v149 offset:55296
    v_mfma_f32_16x16x32_bf16 v[68:71], a[168:171], v[120:123], v[68:71]
    buffer_load_dwordx4 a[8:11], v1, s[4:7], s58 offen offset:2048
    v_mfma_f32_16x16x32_bf16 v[64:67], a[172:175], v[124:127], v[64:67]
    ds_read_b128 v[116:119], v149 offset:56320
    v_mfma_f32_16x16x32_bf16 v[68:71], a[176:179], v[124:127], v[68:71]
    ds_read_b64 v[138:139], v151 offset:384
    s_waitcnt lgkmcnt(5)
    v_mfma_f32_16x16x32_bf16 v[64:67], a[180:183], v[128:131], v[64:67]
    ds_read_b128 v[120:123], v149 offset:57344
    v_cvt_pk_bf16_f32 v144, v72, v73
    v_mfma_f32_16x16x32_bf16 v[68:71], a[184:187], v[128:131], v[68:71]
    buffer_load_dwordx4 a[12:15], v1, s[4:7], s58 offen offset:3072
    v_cvt_pk_bf16_f32 v145, v74, v75
    v_mfma_f32_16x16x32_bf16 v[64:67], a[188:191], v[132:135], v[64:67]
    ds_read_b128 v[124:127], v149 offset:58368
    s_add_u32 s58, s63, 4096
    v_mfma_f32_16x16x32_bf16 v[68:71], a[192:195], v[132:135], v[68:71]
    s_waitcnt lgkmcnt(5)
    v_cvt_pk_bf16_f32 v146, v76, v77
    v_cvt_pk_bf16_f32 v147, v78, v79
    v_mfma_f32_16x16x32_bf16 v[64:67], a[196:199], v[104:107], v[64:67]
    ds_read_b128 v[128:131], v149 offset:59392
    v_mfma_f32_16x16x32_bf16 v[68:71], a[200:203], v[104:107], v[68:71]
    buffer_load_dwordx4 a[16:19], v1, s[4:7], s58 offen offset:0
    v_mfma_f32_16x16x32_bf16 v[64:67], a[204:207], v[108:111], v[64:67]
    ds_read_b128 v[132:135], v149 offset:60416
    v_mfma_f32_16x16x32_bf16 v[68:71], a[208:211], v[108:111], v[68:71]
    s_waitcnt lgkmcnt(5)
    s_waitcnt vmcnt(15)
    s_barrier
    v_mfma_f32_16x16x32_bf16 v[64:67], a[212:215], v[112:115], v[64:67]
    ds_read_b128 v[104:107], v148 offset:0
    v_mfma_f32_16x16x32_bf16 v[68:71], a[216:219], v[112:115], v[68:71]
    buffer_load_dwordx4 a[20:23], v1, s[4:7], s58 offen offset:1024
    v_mfma_f32_16x16x32_bf16 v[64:67], a[220:223], v[116:119], v[64:67]
    ds_read_b128 v[108:111], v148 offset:1024
    v_mfma_f32_16x16x32_bf16 v[68:71], a[224:227], v[116:119], v[68:71]
    s_waitcnt lgkmcnt(4)
    v_mfma_f32_16x16x32_bf16 v[64:67], a[228:231], v[120:123], v[64:67]
    ds_read_b128 v[112:115], v148 offset:2048
    v_mfma_f32_16x16x32_bf16 v[68:71], a[232:235], v[120:123], v[68:71]
    buffer_load_dwordx4 a[24:27], v1, s[4:7], s58 offen offset:2048
    v_mfma_f32_16x16x32_bf16 v[64:67], a[236:239], v[124:127], v[64:67]
    ds_read_b128 v[116:119], v148 offset:3072
    v_mfma_f32_16x16x32_bf16 v[68:71], a[240:243], v[124:127], v[68:71]
    s_waitcnt lgkmcnt(4)
    v_mfma_f32_16x16x32_bf16 v[64:67], a[244:247], v[128:131], v[64:67]
    ds_read_b128 v[120:123], v148 offset:4096
    v_mfma_f32_16x16x32_bf16 v[68:71], a[248:251], v[128:131], v[68:71]
    buffer_load_dwordx4 a[28:31], v1, s[4:7], s58 offen offset:3072
    v_mfma_f32_16x16x32_bf16 v[64:67], a[252:255], v[132:135], v[64:67]
    ds_read_b128 v[124:127], v148 offset:5120
    s_add_u32 s58, s63, 8192
    v_mfma_f32_16x16x32_bf16 v[68:71], v[164:167], v[132:135], v[68:71]
    s_waitcnt lgkmcnt(4)
    ds_write_b128 v150, v[144:147] offset:4352
    v_mfma_f32_16x16x32_bf16 v[72:75], a[100:103], v[104:107], 0
    ds_read_b128 v[128:131], v148 offset:6144
    v_mfma_f32_16x16x32_bf16 v[76:79], a[104:107], v[104:107], 0
    buffer_load_dwordx4 a[32:35], v1, s[4:7], s58 offen offset:0
    v_fmac_f32 v80, v136, v2
    v_mfma_f32_16x16x32_bf16 v[72:75], a[108:111], v[108:111], v[72:75]
    ds_read_b128 v[132:135], v148 offset:7168
    v_fmac_f32 v81, v136, v3
    v_mfma_f32_16x16x32_bf16 v[76:79], a[112:115], v[108:111], v[76:79]
    s_waitcnt lgkmcnt(5)
    v_fmac_f32 v82, v136, v4
    v_fmac_f32 v83, v136, v5
    v_mfma_f32_16x16x32_bf16 v[72:75], a[116:119], v[112:115], v[72:75]
    ds_read_b128 v[104:107], v148 offset:8192
    v_fmac_f32 v84, v136, v6
    v_mfma_f32_16x16x32_bf16 v[76:79], a[120:123], v[112:115], v[76:79]
    buffer_load_dwordx4 a[36:39], v1, s[4:7], s58 offen offset:1024
    v_fmac_f32 v85, v136, v7
    v_mfma_f32_16x16x32_bf16 v[72:75], a[124:127], v[116:119], v[72:75]
    ds_read_b128 v[108:111], v148 offset:9216
    v_fmac_f32 v86, v136, v8
    v_mfma_f32_16x16x32_bf16 v[76:79], a[128:131], v[116:119], v[76:79]
    s_waitcnt lgkmcnt(5)
    v_fmac_f32 v87, v136, v9
    v_mul_f32 v80, v80, v137
    v_mfma_f32_16x16x32_bf16 v[72:75], a[132:135], v[120:123], v[72:75]
    ds_read_b128 v[112:115], v148 offset:10240
    v_mul_f32 v81, v81, v137
    v_mfma_f32_16x16x32_bf16 v[76:79], a[136:139], v[120:123], v[76:79]
    buffer_load_dwordx4 a[40:43], v1, s[4:7], s58 offen offset:2048
    v_mul_f32 v82, v82, v137
    v_mfma_f32_16x16x32_bf16 v[72:75], a[140:143], v[124:127], v[72:75]
    ds_read_b128 v[116:119], v148 offset:11264
    v_mul_f32 v83, v83, v137
    v_mfma_f32_16x16x32_bf16 v[76:79], a[144:147], v[124:127], v[76:79]
    s_waitcnt lgkmcnt(4)
    v_mul_f32 v84, v84, v137
    v_mul_f32 v85, v85, v137
    v_mfma_f32_16x16x32_bf16 v[72:75], a[148:151], v[128:131], v[72:75]
    ds_read_b128 v[120:123], v148 offset:12288
    v_mul_f32 v86, v86, v137
    v_mfma_f32_16x16x32_bf16 v[76:79], a[152:155], v[128:131], v[76:79]
    buffer_load_dwordx4 a[44:47], v1, s[4:7], s58 offen offset:3072
    v_mul_f32 v87, v87, v137
    v_mfma_f32_16x16x32_bf16 v[72:75], a[156:159], v[132:135], v[72:75]
    ds_read_b128 v[124:127], v148 offset:13312
    s_add_u32 s58, s63, 12288
    v_mfma_f32_16x16x32_bf16 v[76:79], a[160:163], v[132:135], v[76:79]
    ds_read_b64 v[136:137], v151 offset:512
    s_waitcnt lgkmcnt(5)
    v_mfma_f32_16x16x32_bf16 v[72:75], a[164:167], v[104:107], v[72:75]
    ds_read_b128 v[128:131], v148 offset:14336
    v_cvt_pk_bf16_f32 v140, v80, v81
    v_mfma_f32_16x16x32_bf16 v[76:79], a[168:171], v[104:107], v[76:79]
    buffer_load_dwordx4 a[48:51], v1, s[4:7], s58 offen offset:0
    v_cvt_pk_bf16_f32 v141, v82, v83
    v_mfma_f32_16x16x32_bf16 v[72:75], a[172:175], v[108:111], v[72:75]
    ds_read_b128 v[132:135], v148 offset:15360
    v_cvt_pk_bf16_f32 v142, v84, v85
    v_mfma_f32_16x16x32_bf16 v[76:79], a[176:179], v[108:111], v[76:79]
    s_waitcnt lgkmcnt(5)
    v_cvt_pk_bf16_f32 v143, v86, v87
    s_mul_i32 s36, s22, 896
    s_add_u32 s36, s36, 38296064
    s_cmp_eq_u32 s24, 0
    s_cselect_b32 s36, s36, 1073741824
    buffer_load_dwordx4 v[160:163], v1, s[4:7], s36 offen sc1
    v_mfma_f32_16x16x32_bf16 v[72:75], a[180:183], v[112:115], v[72:75]
    ds_read_b128 v[104:107], v148 offset:16384
    v_mfma_f32_16x16x32_bf16 v[76:79], a[184:187], v[112:115], v[76:79]
    buffer_load_dwordx4 a[52:55], v1, s[4:7], s58 offen offset:1024
    v_mfma_f32_16x16x32_bf16 v[72:75], a[188:191], v[116:119], v[72:75]
    ds_read_b128 v[108:111], v148 offset:17408
    v_mfma_f32_16x16x32_bf16 v[76:79], a[192:195], v[116:119], v[76:79]
    s_waitcnt lgkmcnt(5)
    v_mfma_f32_16x16x32_bf16 v[72:75], a[196:199], v[120:123], v[72:75]
    ds_read_b128 v[112:115], v148 offset:18432
    v_mfma_f32_16x16x32_bf16 v[76:79], a[200:203], v[120:123], v[76:79]
    buffer_load_dwordx4 a[56:59], v1, s[4:7], s58 offen offset:2048
    v_mfma_f32_16x16x32_bf16 v[72:75], a[204:207], v[124:127], v[72:75]
    ds_read_b128 v[116:119], v148 offset:19456
    v_mfma_f32_16x16x32_bf16 v[76:79], a[208:211], v[124:127], v[76:79]
    s_waitcnt lgkmcnt(4)
    s_waitcnt vmcnt(21)
    s_barrier
    v_mfma_f32_16x16x32_bf16 v[72:75], a[212:215], v[128:131], v[72:75]
    ds_read_b128 v[120:123], v148 offset:20480
    v_mfma_f32_16x16x32_bf16 v[76:79], a[216:219], v[128:131], v[76:79]
    buffer_load_dwordx4 a[60:63], v1, s[4:7], s58 offen offset:3072
    v_mfma_f32_16x16x32_bf16 v[72:75], a[220:223], v[132:135], v[72:75]
    ds_read_b128 v[124:127], v148 offset:21504
    s_add_u32 s58, s63, 16384
    v_mfma_f32_16x16x32_bf16 v[76:79], a[224:227], v[132:135], v[76:79]
    s_waitcnt lgkmcnt(4)
    v_mfma_f32_16x16x32_bf16 v[72:75], a[228:231], v[104:107], v[72:75]
    ds_read_b128 v[128:131], v148 offset:22528
    v_mfma_f32_16x16x32_bf16 v[76:79], a[232:235], v[104:107], v[76:79]
    buffer_load_dwordx4 a[64:67], v1, s[4:7], s58 offen offset:0
    v_mfma_f32_16x16x32_bf16 v[72:75], a[236:239], v[108:111], v[72:75]
    ds_read_b128 v[132:135], v148 offset:23552
    v_mfma_f32_16x16x32_bf16 v[76:79], a[240:243], v[108:111], v[76:79]
    s_waitcnt lgkmcnt(4)
    v_mfma_f32_16x16x32_bf16 v[72:75], a[244:247], v[112:115], v[72:75]
    ds_read_b128 v[104:107], v148 offset:24576
    v_mfma_f32_16x16x32_bf16 v[76:79], a[248:251], v[112:115], v[76:79]
    buffer_load_dwordx4 a[68:71], v1, s[4:7], s58 offen offset:1024
    v_mfma_f32_16x16x32_bf16 v[72:75], a[252:255], v[116:119], v[72:75]
    ds_read_b128 v[108:111], v148 offset:25600
    v_mfma_f32_16x16x32_bf16 v[76:79], v[164:167], v[116:119], v[76:79]
    s_waitcnt lgkmcnt(4)
    ds_write_b128 v150, v[140:143] offset:8704
    v_mfma_f32_16x16x32_bf16 v[80:83], a[100:103], v[120:123], 0
    ds_read_b128 v[112:115], v148 offset:26624
    v_mfma_f32_16x16x32_bf16 v[84:87], a[104:107], v[120:123], 0
    buffer_load_dwordx4 a[72:75], v1, s[4:7], s58 offen offset:2048
    v_fmac_f32 v88, v138, v2
    v_mfma_f32_16x16x32_bf16 v[80:83], a[108:111], v[124:127], v[80:83]
    ds_read_b128 v[116:119], v148 offset:27648
    v_fmac_f32 v89, v138, v3
    v_mfma_f32_16x16x32_bf16 v[84:87], a[112:115], v[124:127], v[84:87]
    s_waitcnt lgkmcnt(5)
    v_fmac_f32 v90, v138, v4
    v_fmac_f32 v91, v138, v5
    v_mfma_f32_16x16x32_bf16 v[80:83], a[116:119], v[128:131], v[80:83]
    ds_read_b128 v[120:123], v148 offset:28672
    v_fmac_f32 v92, v138, v6
    v_mfma_f32_16x16x32_bf16 v[84:87], a[120:123], v[128:131], v[84:87]
    buffer_load_dwordx4 a[76:79], v1, s[4:7], s58 offen offset:3072
    v_fmac_f32 v93, v138, v7
    v_mfma_f32_16x16x32_bf16 v[80:83], a[124:127], v[132:135], v[80:83]
    ds_read_b128 v[124:127], v148 offset:29696
    s_add_u32 s58, s63, 20480
    v_mfma_f32_16x16x32_bf16 v[84:87], a[128:131], v[132:135], v[84:87]
    s_waitcnt lgkmcnt(5)
    v_fmac_f32 v94, v138, v8
    v_fmac_f32 v95, v138, v9
    v_mfma_f32_16x16x32_bf16 v[80:83], a[132:135], v[104:107], v[80:83]
    ds_read_b128 v[128:131], v148 offset:30720
    v_mul_f32 v88, v88, v139
    v_mfma_f32_16x16x32_bf16 v[84:87], a[136:139], v[104:107], v[84:87]
    buffer_load_dwordx4 a[80:83], v1, s[4:7], s58 offen offset:0
    v_mul_f32 v89, v89, v139
    v_mfma_f32_16x16x32_bf16 v[80:83], a[140:143], v[108:111], v[80:83]
    ds_read_b128 v[132:135], v148 offset:31744
    v_mul_f32 v90, v90, v139
    v_mfma_f32_16x16x32_bf16 v[84:87], a[144:147], v[108:111], v[84:87]
    s_waitcnt lgkmcnt(4)
    v_mul_f32 v91, v91, v139
    v_mul_f32 v92, v92, v139
    v_mfma_f32_16x16x32_bf16 v[80:83], a[148:151], v[112:115], v[80:83]
    ds_read_b128 v[104:107], v148 offset:32768
    v_mul_f32 v93, v93, v139
    v_mfma_f32_16x16x32_bf16 v[84:87], a[152:155], v[112:115], v[84:87]
    buffer_load_dwordx4 a[84:87], v1, s[4:7], s58 offen offset:1024
    v_mul_f32 v94, v94, v139
    v_mfma_f32_16x16x32_bf16 v[80:83], a[156:159], v[116:119], v[80:83]
    ds_read_b128 v[108:111], v148 offset:33792
    v_mul_f32 v95, v95, v139
    v_mfma_f32_16x16x32_bf16 v[84:87], a[160:163], v[116:119], v[84:87]
    ds_read_b64 v[138:139], v151 offset:640
    s_waitcnt lgkmcnt(5)
    v_mfma_f32_16x16x32_bf16 v[80:83], a[164:167], v[120:123], v[80:83]
    ds_read_b128 v[112:115], v148 offset:34816
    v_cvt_pk_bf16_f32 v144, v88, v89
    v_mfma_f32_16x16x32_bf16 v[84:87], a[168:171], v[120:123], v[84:87]
    buffer_load_dwordx4 a[88:91], v1, s[4:7], s58 offen offset:2048
    v_cvt_pk_bf16_f32 v145, v90, v91
    v_mfma_f32_16x16x32_bf16 v[80:83], a[172:175], v[124:127], v[80:83]
    ds_read_b128 v[116:119], v148 offset:35840
    v_cvt_pk_bf16_f32 v146, v92, v93
    v_mfma_f32_16x16x32_bf16 v[84:87], a[176:179], v[124:127], v[84:87]
    s_waitcnt lgkmcnt(5)
    v_cvt_pk_bf16_f32 v147, v94, v95
    v_mfma_f32_16x16x32_bf16 v[80:83], a[180:183], v[128:131], v[80:83]
    ds_read_b128 v[120:123], v148 offset:36864
    v_mfma_f32_16x16x32_bf16 v[84:87], a[184:187], v[128:131], v[84:87]
    buffer_load_dwordx4 a[92:95], v1, s[4:7], s58 offen offset:3072
    v_mfma_f32_16x16x32_bf16 v[80:83], a[188:191], v[132:135], v[80:83]
    ds_read_b128 v[124:127], v148 offset:37888
    s_add_u32 s58, s63, 24576
    v_mfma_f32_16x16x32_bf16 v[84:87], a[192:195], v[132:135], v[84:87]
    s_waitcnt lgkmcnt(5)
    s_waitcnt vmcnt(11)
    s_cmp_lg_u32 s24, 0
    s_cbranch_scc1 p0_27
    s_mov_b32 s3, 0
    s_nop 2
ls_28:
    s_mov_b64 s[50:51], 0
    v_cmp_ne_u64 vcc, s[100:101], v[160:161]
    s_nop 0
    s_or_b64 s[50:51], s[50:51], vcc
    v_cmp_ne_u64 vcc, s[100:101], v[162:163]
    s_nop 0
    s_or_b64 s[50:51], s[50:51], vcc
    s_and_b32 s51, s51, 0xffffff
    s_cmp_eq_u64 s[50:51], 0
    s_cbranch_scc1 lsd_29
    s_add_u32 s3, s3, 1
    s_cmp_gt_u32 s3, 100000
    s_cbranch_scc1 lsd_29
    s_sleep 4
    buffer_load_dwordx4 v[160:163], v1, s[4:7], s36 offen sc1
    s_waitcnt vmcnt(0)
    s_branch ls_28
    s_nop 0
lsd_29:
p0_27:
    v_mfma_f32_16x16x32_bf16 v[80:83], a[196:199], v[104:107], v[80:83]
    ds_read_b128 v[128:131], v148 offset:38912
    v_mfma_f32_16x16x32_bf16 v[84:87], a[200:203], v[104:107], v[84:87]
    buffer_load_dwordx4 a[96:99], v1, s[4:7], s58 offen offset:0
    v_mfma_f32_16x16x32_bf16 v[80:83], a[204:207], v[108:111], v[80:83]
    ds_read_b128 v[132:135], v148 offset:39936
    s_add_u32 s58, s88, 0
    v_mfma_f32_16x16x32_bf16 v[84:87], a[208:211], v[108:111], v[84:87]
    s_waitcnt lgkmcnt(4)
    s_barrier
    v_mfma_f32_16x16x32_bf16 v[80:83], a[212:215], v[112:115], v[80:83]
    ds_read_b128 v[104:107], v148 offset:40960
    v_mfma_f32_16x16x32_bf16 v[84:87], a[216:219], v[112:115], v[84:87]
    buffer_load_dwordx4 v[168:171], v1, s[4:7], s58 offen offset:0
    v_mfma_f32_16x16x32_bf16 v[80:83], a[220:223], v[116:119], v[80:83]
    ds_read_b128 v[108:111], v148 offset:41984
    v_mfma_f32_16x16x32_bf16 v[84:87], a[224:227], v[116:119], v[84:87]
    s_waitcnt lgkmcnt(4)
    v_mfma_f32_16x16x32_bf16 v[80:83], a[228:231], v[120:123], v[80:83]
    ds_read_b128 v[112:115], v148 offset:43008
    v_mfma_f32_16x16x32_bf16 v[84:87], a[232:235], v[120:123], v[84:87]
    buffer_load_dwordx4 v[172:175], v1, s[4:7], s58 offen offset:1024
    v_mfma_f32_16x16x32_bf16 v[80:83], a[236:239], v[124:127], v[80:83]
    ds_read_b128 v[116:119], v148 offset:44032
    v_mfma_f32_16x16x32_bf16 v[84:87], a[240:243], v[124:127], v[84:87]
    s_waitcnt lgkmcnt(4)
    v_mfma_f32_16x16x32_bf16 v[80:83], a[244:247], v[128:131], v[80:83]
    ds_read_b128 v[120:123], v148 offset:45056
    v_mfma_f32_16x16x32_bf16 v[84:87], a[248:251], v[128:131], v[84:87]
    buffer_load_dwordx4 v[176:179], v1, s[4:7], s58 offen offset:2048
    v_mfma_f32_16x16x32_bf16 v[80:83], a[252:255], v[132:135], v[80:83]
    ds_read_b128 v[124:127], v148 offset:46080
    v_mfma_f32_16x16x32_bf16 v[84:87], v[164:167], v[132:135], v[84:87]
    s_waitcnt lgkmcnt(4)
    ds_write_b128 v150, v[144:147] offset:13056
    v_mfma_f32_16x16x32_bf16 v[88:91], a[100:103], v[104:107], 0
    ds_read_b128 v[128:131], v148 offset:47104
    v_mfma_f32_16x16x32_bf16 v[92:95], a[104:107], v[104:107], 0
    buffer_load_dwordx4 v[180:183], v1, s[4:7], s58 offen offset:3072
    v_fmac_f32 v96, v136, v2
    v_mfma_f32_16x16x32_bf16 v[88:91], a[108:111], v[108:111], v[88:91]
    ds_read_b128 v[132:135], v148 offset:48128
    s_add_u32 s58, s88, 4096
    v_mfma_f32_16x16x32_bf16 v[92:95], a[112:115], v[108:111], v[92:95]
    s_waitcnt lgkmcnt(5)
    v_fmac_f32 v97, v136, v3
    v_fmac_f32 v98, v136, v4
    v_mfma_f32_16x16x32_bf16 v[88:91], a[116:119], v[112:115], v[88:91]
    ds_read_b128 v[104:107], v148 offset:49152
    v_fmac_f32 v99, v136, v5
    v_mfma_f32_16x16x32_bf16 v[92:95], a[120:123], v[112:115], v[92:95]
    buffer_load_dwordx4 v[184:187], v1, s[4:7], s58 offen offset:0
    v_fmac_f32 v100, v136, v6
    v_mfma_f32_16x16x32_bf16 v[88:91], a[124:127], v[116:119], v[88:91]
    ds_read_b128 v[108:111], v148 offset:50176
    v_fmac_f32 v101, v136, v7
    v_mfma_f32_16x16x32_bf16 v[92:95], a[128:131], v[116:119], v[92:95]
    s_waitcnt lgkmcnt(5)
    v_fmac_f32 v102, v136, v8
    v_fmac_f32 v103, v136, v9
    v_mfma_f32_16x16x32_bf16 v[88:91], a[132:135], v[120:123], v[88:91]
    ds_read_b128 v[112:115], v148 offset:51200
    v_mul_f32 v96, v96, v137
    v_mfma_f32_16x16x32_bf16 v[92:95], a[136:139], v[120:123], v[92:95]
    buffer_load_dwordx4 v[188:191], v1, s[4:7], s58 offen offset:1024
    v_mul_f32 v97, v97, v137
    v_mfma_f32_16x16x32_bf16 v[88:91], a[140:143], v[124:127], v[88:91]
    ds_read_b128 v[116:119], v148 offset:52224
    v_mul_f32 v98, v98, v137
    v_mfma_f32_16x16x32_bf16 v[92:95], a[144:147], v[124:127], v[92:95]
    s_waitcnt lgkmcnt(4)
    v_mul_f32 v99, v99, v137
    v_mul_f32 v100, v100, v137
    v_mfma_f32_16x16x32_bf16 v[88:91], a[148:151], v[128:131], v[88:91]
    ds_read_b128 v[120:123], v148 offset:53248
    v_mul_f32 v101, v101, v137
    v_mfma_f32_16x16x32_bf16 v[92:95], a[152:155], v[128:131], v[92:95]
    buffer_load_dwordx4 v[192:195], v1, s[4:7], s58 offen offset:2048
    v_mul_f32 v102, v102, v137
    v_mfma_f32_16x16x32_bf16 v[88:91], a[156:159], v[132:135], v[88:91]
    ds_read_b128 v[124:127], v148 offset:54272
    v_mul_f32 v103, v103, v137
    v_mfma_f32_16x16x32_bf16 v[92:95], a[160:163], v[132:135], v[92:95]
    ds_read_b64 v[136:137], v151 offset:768
    s_waitcnt lgkmcnt(5)
    v_mfma_f32_16x16x32_bf16 v[88:91], a[164:167], v[104:107], v[88:91]
    ds_read_b128 v[128:131], v148 offset:55296
    v_cvt_pk_bf16_f32 v140, v96, v97
    v_mfma_f32_16x16x32_bf16 v[92:95], a[168:171], v[104:107], v[92:95]
    buffer_load_dwordx4 v[196:199], v1, s[4:7], s58 offen offset:3072
    v_cvt_pk_bf16_f32 v141, v98, v99
    v_mfma_f32_16x16x32_bf16 v[88:91], a[172:175], v[108:111], v[88:91]
    ds_read_b128 v[132:135], v148 offset:56320
    s_add_u32 s58, s88, 8192
    v_mfma_f32_16x16x32_bf16 v[92:95], a[176:179], v[108:111], v[92:95]
    s_waitcnt lgkmcnt(5)
    v_cvt_pk_bf16_f32 v142, v100, v101
    v_cvt_pk_bf16_f32 v143, v102, v103
    v_mfma_f32_16x16x32_bf16 v[88:91], a[180:183], v[112:115], v[88:91]
    ds_read_b128 v[104:107], v148 offset:57344
    v_mfma_f32_16x16x32_bf16 v[92:95], a[184:187], v[112:115], v[92:95]
    buffer_load_dwordx4 v[200:203], v1, s[4:7], s58 offen offset:0
    v_mfma_f32_16x16x32_bf16 v[88:91], a[188:191], v[116:119], v[88:91]
    ds_read_b128 v[108:111], v148 offset:58368
    v_mfma_f32_16x16x32_bf16 v[92:95], a[192:195], v[116:119], v[92:95]
    s_waitcnt lgkmcnt(5)
    v_mfma_f32_16x16x32_bf16 v[88:91], a[196:199], v[120:123], v[88:91]
    ds_read_b128 v[112:115], v148 offset:59392
    v_mfma_f32_16x16x32_bf16 v[92:95], a[200:203], v[120:123], v[92:95]
    buffer_load_dwordx4 v[204:207], v1, s[4:7], s58 offen offset:1024
    v_mfma_f32_16x16x32_bf16 v[88:91], a[204:207], v[124:127], v[88:91]
    ds_read_b128 v[116:119], v148 offset:60416
    v_mfma_f32_16x16x32_bf16 v[92:95], a[208:211], v[124:127], v[92:95]
    s_waitcnt lgkmcnt(4)
    v_mfma_f32_16x16x32_bf16 v[88:91], a[212:215], v[128:131], v[88:91]
    ds_write_b128 v150, v[140:143] offset:17408
    v_mfma_f32_16x16x32_bf16 v[92:95], a[216:219], v[128:131], v[92:95]
    buffer_load_dwordx4 v[208:211], v1, s[4:7], s58 offen offset:2048
    v_mfma_f32_16x16x32_bf16 v[88:91], a[220:223], v[132:135], v[88:91]
    v_fmac_f32 v64, v138, v2
    v_fmac_f32 v65, v138, v3
    v_mfma_f32_16x16x32_bf16 v[92:95], a[224:227], v[132:135], v[92:95]
    s_waitcnt lgkmcnt(3)
    v_fmac_f32 v66, v138, v4
    v_fmac_f32 v67, v138, v5
    v_mfma_f32_16x16x32_bf16 v[88:91], a[228:231], v[104:107], v[88:91]
    v_fmac_f32 v68, v138, v6
    v_fmac_f32 v69, v138, v7
    v_mfma_f32_16x16x32_bf16 v[92:95], a[232:235], v[104:107], v[92:95]
    buffer_load_dwordx4 v[212:215], v1, s[4:7], s58 offen offset:3072
    v_fmac_f32 v70, v138, v8
    v_mfma_f32_16x16x32_bf16 v[88:91], a[236:239], v[108:111], v[88:91]
    s_add_u32 s58, s88, 12288
    v_fmac_f32 v71, v138, v9
    v_mul_f32 v64, v64, v139
    v_mfma_f32_16x16x32_bf16 v[92:95], a[240:243], v[108:111], v[92:95]
    s_waitcnt lgkmcnt(1)
    v_mul_f32 v65, v65, v139
    v_mul_f32 v66, v66, v139
    v_mfma_f32_16x16x32_bf16 v[88:91], a[244:247], v[112:115], v[88:91]
    v_mul_f32 v67, v67, v139
    v_mul_f32 v68, v68, v139
    v_mfma_f32_16x16x32_bf16 v[92:95], a[248:251], v[112:115], v[92:95]
    buffer_load_dwordx4 v[216:219], v1, s[4:7], s58 offen offset:0
    v_mul_f32 v69, v69, v139
    v_mfma_f32_16x16x32_bf16 v[88:91], a[252:255], v[116:119], v[88:91]
    v_mul_f32 v70, v70, v139
    v_mul_f32 v71, v71, v139
    v_mfma_f32_16x16x32_bf16 v[92:95], v[164:167], v[116:119], v[92:95]
    ds_read_b64 v[138:139], v151 offset:896
    v_cvt_pk_bf16_f32 v144, v64, v65
    v_cvt_pk_bf16_f32 v145, v66, v67
    v_cvt_pk_bf16_f32 v146, v68, v69
    v_cvt_pk_bf16_f32 v147, v70, v71
    ds_write_b128 v150, v[144:147] offset:21760
    v_fmac_f32 v72, v136, v2
    v_fmac_f32 v73, v136, v3
    v_fmac_f32 v74, v136, v4
    v_fmac_f32 v75, v136, v5
    v_fmac_f32 v76, v136, v6
    v_fmac_f32 v77, v136, v7
    v_fmac_f32 v78, v136, v8
    v_fmac_f32 v79, v136, v9
    v_mul_f32 v72, v72, v137
    v_mul_f32 v73, v73, v137
    v_mul_f32 v74, v74, v137
    v_mul_f32 v75, v75, v137
    v_mul_f32 v76, v76, v137
    v_mul_f32 v77, v77, v137
    v_mul_f32 v78, v78, v137
    v_mul_f32 v79, v79, v137
    ds_read_b64 v[136:137], v151 offset:1024
    v_cvt_pk_bf16_f32 v140, v72, v73
    v_cvt_pk_bf16_f32 v141, v74, v75
    v_cvt_pk_bf16_f32 v142, v76, v77
    v_cvt_pk_bf16_f32 v143, v78, v79
    ds_write_b128 v150, v[140:143] offset:26112
    s_waitcnt lgkmcnt(3)
    v_fmac_f32 v80, v138, v2
    v_fmac_f32 v81, v138, v3
    v_fmac_f32 v82, v138, v4
    v_fmac_f32 v83, v138, v5
    v_fmac_f32 v84, v138, v6
    v_fmac_f32 v85, v138, v7
    v_fmac_f32 v86, v138, v8
    v_fmac_f32 v87, v138, v9
    v_mul_f32 v80, v80, v139
    v_mul_f32 v81, v81, v139
    v_mul_f32 v82, v82, v139
    v_mul_f32 v83, v83, v139
    v_mul_f32 v84, v84, v139
    v_mul_f32 v85, v85, v139
    v_mul_f32 v86, v86, v139
    v_mul_f32 v87, v87, v139
    v_cvt_pk_bf16_f32 v144, v80, v81
    v_cvt_pk_bf16_f32 v145, v82, v83
    v_cvt_pk_bf16_f32 v146, v84, v85
    v_cvt_pk_bf16_f32 v147, v86, v87
    ds_write_b128 v150, v[144:147] offset:30464
    buffer_load_dwordx4 v[220:223], v1, s[4:7], s58 offen offset:1024
    buffer_load_dwordx4 v[224:227], v1, s[4:7], s58 offen offset:2048
    buffer_load_dwordx4 v[228:231], v1, s[4:7], s58 offen offset:3072
    s_add_u32 s58, s88, 16384
    buffer_load_dwordx4 v[232:235], v1, s[4:7], s58 offen offset:0
    buffer_load_dwordx4 v[236:239], v1, s[4:7], s58 offen offset:1024
    buffer_load_dwordx4 v[240:243], v1, s[4:7], s58 offen offset:2048
    buffer_load_dwordx4 v[244:247], v1, s[4:7], s58 offen offset:3072
    s_add_u32 s58, s88, 20480
    buffer_load_dwordx4 v[248:251], v1, s[4:7], s58 offen offset:0
    s_waitcnt lgkmcnt(2)
    v_pk_fma_f32 v[88:89], v[136:137], v[2:3], v[88:89] op_sel_hi:[0,1,1]
    v_pk_fma_f32 v[90:91], v[136:137], v[4:5], v[90:91] op_sel_hi:[0,1,1]
    v_pk_fma_f32 v[92:93], v[136:137], v[6:7], v[92:93] op_sel_hi:[0,1,1]
    v_pk_fma_f32 v[94:95], v[136:137], v[8:9], v[94:95] op_sel_hi:[0,1,1]
    v_pk_mul_f32 v[88:89], v[136:137], v[88:89] op_sel:[1,0]
    v_pk_mul_f32 v[90:91], v[136:137], v[90:91] op_sel:[1,0]
    v_pk_mul_f32 v[92:93], v[136:137], v[92:93] op_sel:[1,0]
    v_pk_mul_f32 v[94:95], v[136:137], v[94:95] op_sel:[1,0]
    v_cvt_pk_bf16_f32 v140, v88, v89
    v_cvt_pk_bf16_f32 v141, v90, v91
    v_cvt_pk_bf16_f32 v142, v92, v93
    v_cvt_pk_bf16_f32 v143, v94, v95
    ds_write_b128 v150, v[140:143] offset:34816
    s_waitcnt lgkmcnt(0)
    s_barrier
    ds_read_b128 v[64:67], v152 offset:4352
    ds_read_b128 v[68:71], v154 offset:0
    ds_read_b128 v[72:75], v154 offset:4352
    ds_read_b128 v[84:87], v153 offset:4352
    ds_read_b128 v[88:91], v154 offset:80
    ds_read_b128 v[92:95], v154 offset:4432
    ds_read_b128 v[104:107], v152 offset:21760
    ds_read_b128 v[108:111], v154 offset:17408
    ds_read_b128 v[112:115], v154 offset:21760
    ds_read_b128 v[124:127], v153 offset:21760
    ds_read_b128 v[128:131], v154 offset:17488
    ds_read_b128 v[132:135], v154 offset:21840
    s_waitcnt lgkmcnt(9)
    v_mfma_f32_16x16x32_bf16 v[76:79], v[68:71], v[64:67], v[54:57]
    v_mfma_f32_16x16x32_bf16 v[80:83], v[72:75], v[64:67], v[46:49]
    s_waitcnt lgkmcnt(6)
    v_mfma_f32_16x16x32_bf16 v[96:99], v[88:91], v[84:87], v[54:57]
    v_mfma_f32_16x16x32_bf16 v[100:103], v[92:95], v[84:87], v[46:49]
    s_waitcnt lgkmcnt(3)
    v_mfma_f32_16x16x32_bf16 v[116:119], v[108:111], v[104:107], v[50:53]
    buffer_load_dwordx4 v[252:255], v1, s[4:7], s58 offen offset:1024
    v_mfma_f32_16x16x32_bf16 v[120:123], v[112:115], v[104:107], v[46:49]
    s_waitcnt lgkmcnt(0)
    v_mfma_f32_16x16x32_bf16 v[136:139], v[128:131], v[124:127], v[50:53]
    v_mfma_f32_16x16x32_bf16 v[140:143], v[132:135], v[124:127], v[46:49]
    ds_read_b64_tr_b16 v[68:69], v155 offset:112
    ds_read_b64_tr_b16 v[72:73], v156 offset:152
    ds_read_b64_tr_b16 v[70:71], v155 offset:4464
    ds_read_b64_tr_b16 v[74:75], v156 offset:4504
    ds_read_b64_tr_b16 v[88:89], v155 offset:192
    ds_read_b64_tr_b16 v[92:93], v156 offset:232
    ds_read_b64_tr_b16 v[90:91], v155 offset:4544
    ds_read_b64_tr_b16 v[94:95], v156 offset:4584
    ds_read_b64_tr_b16 v[108:109], v155 offset:17520
    ds_read_b64_tr_b16 v[112:113], v156 offset:17560
    ds_read_b64_tr_b16 v[110:111], v155 offset:21872
    ds_read_b64_tr_b16 v[114:115], v156 offset:21912
    ds_read_b64_tr_b16 v[128:129], v155 offset:17600
    ds_read_b64_tr_b16 v[132:133], v156 offset:17640
    ds_read_b64_tr_b16 v[130:131], v155 offset:21952
    ds_read_b64_tr_b16 v[134:135], v156 offset:21992
    s_add_u32 s58, s88, 20480
    buffer_load_dwordx4 a[168:171], v1, s[4:7], s58 offen offset:2048
    v_max_f32 v76, v76, v80
    v_max_f32 v96, v96, v100
    v_max_f32 v116, v116, v120
    v_max_f32 v136, v136, v140
    v_max_f32 v77, v77, v81
    v_max_f32 v97, v97, v101
    v_max_f32 v117, v117, v121
    v_max_f32 v137, v137, v141
    v_max_f32 v78, v78, v82
    v_max_f32 v98, v98, v102
    v_max_f32 v118, v118, v122
    v_max_f32 v138, v138, v142
    v_max_f32 v79, v79, v83
    v_max_f32 v99, v99, v103
    v_max_f32 v119, v119, v123
    v_max_f32 v139, v139, v143
    v_max3_f32 v80, v76, v77, v78
    v_max3_f32 v100, v96, v97, v98
    v_max3_f32 v120, v116, v117, v118
    v_max3_f32 v140, v136, v137, v138
    buffer_load_dwordx4 a[100:103], v1, s[4:7], s58 offen offset:3072
    v_max_f32 v80, v80, v79
    v_max_f32 v100, v100, v99
    v_max_f32 v120, v120, v119
    v_max_f32 v140, v140, v139
    v_permlane32_swap_b32 v80, v100
    s_nop 0
    v_permlane32_swap_b32 v120, v140
    v_max_f32 v80, v80, v100
    v_max_f32 v120, v120, v140
    s_nop 1
    v_permlane16_swap_b32 v80, v120
    v_max_f32 v80, v80, v120
    v_mul_f32 v80, s48, v80
    v_mov_b32 v120, v80
    s_nop 1
    v_permlane16_swap_b32 v80, v120
    v_mov_b32 v100, v80
    v_mov_b32 v140, v120
    s_nop 0
    v_permlane32_swap_b32 v80, v100
    v_permlane32_swap_b32 v120, v140
    v_fma_f32 v76, v76, s48, -v80
    v_fma_f32 v96, v96, s48, -v100
    v_fma_f32 v116, v116, s48, -v120
    s_add_u32 s58, s88, 24576
    buffer_load_dwordx4 a[104:107], v1, s[4:7], s58 offen offset:0
    v_fma_f32 v136, v136, s48, -v140
    v_fma_f32 v77, v77, s48, -v80
    v_fma_f32 v97, v97, s48, -v100
    v_fma_f32 v117, v117, s48, -v120
    v_fma_f32 v137, v137, s48, -v140
    v_fma_f32 v78, v78, s48, -v80
    v_fma_f32 v98, v98, s48, -v100
    v_fma_f32 v118, v118, s48, -v120
    v_fma_f32 v138, v138, s48, -v140
    v_fma_f32 v79, v79, s48, -v80
    v_fma_f32 v99, v99, s48, -v100
    v_fma_f32 v119, v119, s48, -v120
    v_fma_f32 v139, v139, s48, -v140
    v_exp_f32 v76, v76
    v_exp_f32 v96, v96
    v_exp_f32 v116, v116
    v_exp_f32 v136, v136
    v_exp_f32 v77, v77
    v_exp_f32 v97, v97
    v_exp_f32 v117, v117
    v_exp_f32 v137, v137
    v_exp_f32 v78, v78
    v_exp_f32 v98, v98
    v_exp_f32 v118, v118
    v_exp_f32 v138, v138
    v_exp_f32 v79, v79
    v_exp_f32 v99, v99
    v_exp_f32 v119, v119
    v_exp_f32 v139, v139
    v_mov_b32 v144, 0x3f803f80
    v_mov_b32 v145, 0x3f803f80
    v_mov_b32 v146, 0x3f803f80
    v_mov_b32 v147, 0x3f803f80
    v_cvt_pk_bf16_f32 v80, v76, v77
    v_cvt_pk_bf16_f32 v100, v96, v97
    v_cvt_pk_bf16_f32 v120, v116, v117
    v_cvt_pk_bf16_f32 v140, v136, v137
    v_cvt_pk_bf16_f32 v81, v78, v79
    v_cvt_pk_bf16_f32 v101, v98, v99
    v_cvt_pk_bf16_f32 v121, v118, v119
    v_cvt_pk_bf16_f32 v141, v138, v139
    v_and_b32 v64, v80, v58
    v_and_b32 v84, v100, v58
    v_and_b32 v104, v120, v58
    v_and_b32 v124, v140, v58
    v_and_b32 v65, v81, v59
    v_and_b32 v85, v101, v59
    v_and_b32 v105, v121, v59
    v_and_b32 v125, v141, v59
    v_and_b32 v66, v80, v60
    v_and_b32 v86, v100, v60
    v_and_b32 v106, v120, v60
    v_and_b32 v126, v140, v60
    v_and_b32 v67, v81, v61
    v_and_b32 v87, v101, v61
    v_and_b32 v107, v121, v61
    v_and_b32 v127, v141, v61
    s_waitcnt lgkmcnt(12)
    v_mfma_f32_16x16x32_bf16 v[76:79], v[68:71], v[64:67], 0
    v_mfma_f32_16x16x32_bf16 v[80:83], v[72:75], v[64:67], 0
    s_waitcnt lgkmcnt(8)
    v_mfma_f32_16x16x32_bf16 v[96:99], v[88:91], v[84:87], 0
    v_mfma_f32_16x16x32_bf16 v[100:103], v[92:95], v[84:87], 0
    s_waitcnt lgkmcnt(4)
    v_mfma_f32_16x16x32_bf16 v[116:119], v[108:111], v[104:107], 0
    v_mfma_f32_16x16x32_bf16 v[120:123], v[112:115], v[104:107], 0
    s_waitcnt lgkmcnt(0)
    v_mfma_f32_16x16x32_bf16 v[136:139], v[128:131], v[124:127], 0
    v_mfma_f32_16x16x32_bf16 v[140:143], v[132:135], v[124:127], 0
    v_mfma_f32_16x16x32_bf16 v[72:75], v[144:147], v[64:67], 0
    v_mfma_f32_16x16x32_bf16 v[92:95], v[144:147], v[84:87], 0
    v_mfma_f32_16x16x32_bf16 v[112:115], v[144:147], v[104:107], 0
    v_mfma_f32_16x16x32_bf16 v[132:135], v[144:147], v[124:127], 0
    s_add_u32 s55, s47, 0
    s_add_u32 s54, s47, 81920
    s_nop 2
    v_rcp_f32 v72, v72
    v_rcp_f32 v92, v92
    v_rcp_f32 v112, v112
    v_rcp_f32 v132, v132
    v_pk_mul_f32 v[76:77], v[76:77], v[72:73] op_sel_hi:[1,0]
    v_pk_mul_f32 v[78:79], v[78:79], v[72:73] op_sel_hi:[1,0]
    v_pk_mul_f32 v[80:81], v[80:81], v[72:73] op_sel_hi:[1,0]
    v_pk_mul_f32 v[82:83], v[82:83], v[72:73] op_sel_hi:[1,0]
    v_pk_mul_f32 v[96:97], v[96:97], v[92:93] op_sel_hi:[1,0]
    v_pk_mul_f32 v[98:99], v[98:99], v[92:93] op_sel_hi:[1,0]
    v_pk_mul_f32 v[100:101], v[100:101], v[92:93] op_sel_hi:[1,0]
    v_pk_mul_f32 v[102:103], v[102:103], v[92:93] op_sel_hi:[1,0]
    v_pk_mul_f32 v[116:117], v[116:117], v[112:113] op_sel_hi:[1,0]
    v_pk_mul_f32 v[118:119], v[118:119], v[112:113] op_sel_hi:[1,0]
    v_pk_mul_f32 v[120:121], v[120:121], v[112:113] op_sel_hi:[1,0]
    v_pk_mul_f32 v[122:123], v[122:123], v[112:113] op_sel_hi:[1,0]
    v_pk_mul_f32 v[136:137], v[136:137], v[132:133] op_sel_hi:[1,0]
    v_pk_mul_f32 v[138:139], v[138:139], v[132:133] op_sel_hi:[1,0]
    v_pk_mul_f32 v[140:141], v[140:141], v[132:133] op_sel_hi:[1,0]
    v_pk_mul_f32 v[142:143], v[142:143], v[132:133] op_sel_hi:[1,0]
    v_cvt_pk_bf16_f32 v64, v76, v77
    v_cvt_pk_bf16_f32 v65, v78, v79
    v_cvt_pk_bf16_f32 v68, v80, v81
    v_cvt_pk_bf16_f32 v69, v82, v83
    v_cvt_pk_bf16_f32 v66, v96, v97
    v_cvt_pk_bf16_f32 v67, v98, v99
    v_cvt_pk_bf16_f32 v70, v100, v101
    v_cvt_pk_bf16_f32 v71, v102, v103
    buffer_store_dwordx4 v[64:67], v1, s[4:7], s55 offen sc1
    buffer_store_dwordx4 v[68:71], v157, s[4:7], s55 offen offset:1024 sc1
    v_cvt_pk_bf16_f32 v104, v116, v117
    v_cvt_pk_bf16_f32 v105, v118, v119
    v_cvt_pk_bf16_f32 v108, v120, v121
    v_cvt_pk_bf16_f32 v109, v122, v123
    v_cvt_pk_bf16_f32 v106, v136, v137
    v_cvt_pk_bf16_f32 v107, v138, v139
    v_cvt_pk_bf16_f32 v110, v140, v141
    v_cvt_pk_bf16_f32 v111, v142, v143
    buffer_store_dwordx4 v[104:107], v1, s[4:7], s54 offen sc1
    buffer_store_dwordx4 v[108:111], v157, s[4:7], s54 offen offset:1024 sc1
    s_add_u32 s95, s95, 1
    v_mov_b32 v162, s95
    s_mov_b64 exec, 1
    s_cmp_eq_u32 s23, 0
    s_cbranch_scc1 slow_30
    s_waitcnt vmcnt(0)
    buffer_store_dword v162, v63, s[4:7], s60 offen
    s_branch join_31
    s_nop 0
slow_30:
    s_waitcnt vmcnt(0)
    buffer_store_dword v162, v63, s[4:7], s60 offen sc1
    s_nop 1
join_31:
    s_mov_b64 exec, -1
    buffer_load_dwordx4 a[108:111], v1, s[4:7], s58 offen offset:1024
    buffer_load_dwordx4 a[112:115], v1, s[4:7], s58 offen offset:2048
    buffer_load_dwordx4 a[116:119], v1, s[4:7], s58 offen offset:3072
    s_add_u32 s58, s88, 28672
    buffer_load_dwordx4 a[120:123], v1, s[4:7], s58 offen offset:0
    buffer_load_dwordx4 a[124:127], v1, s[4:7], s58 offen offset:1024
    buffer_load_dwordx4 a[128:131], v1, s[4:7], s58 offen offset:2048
    buffer_load_dwordx4 a[132:135], v1, s[4:7], s58 offen offset:3072
    s_add_u32 s58, s88, 32768
    buffer_load_dwordx4 a[136:139], v1, s[4:7], s58 offen offset:0
    s_lshl_b32 s40, s20, 3
    s_lshr_b32 s3, s21, 3
    s_lshl_b32 s3, s3, 2
    s_add_u32 s40, s40, s3
    s_mul_i32 s40, s40, 20
    s_mul_i32 s3, s22, 5
    s_add_u32 s40, s40, s3
    s_lshl_b32 s40, s40, 10
    s_mul_i32 s3, s24, 2621440
    s_add_u32 s40, s40, s3
    s_add_u32 s40, s40, 18350080
    s_add_u32 s3, s22, 1
    s_and_b32 s3, s3, 3
    s_mul_i32 s41, s3, 20480
    s_add_u32 s41, s41, s40
    s_mul_i32 s52, s3, 15360
    s_add_u32 s3, s22, 2
    s_and_b32 s3, s3, 3
    s_mul_i32 s42, s3, 20480
    s_add_u32 s42, s42, s40
    s_mul_i32 s53, s3, 15360
    s_add_u32 s3, s22, 3
    s_and_b32 s3, s3, 3
    s_mul_i32 s43, s3, 20480
    s_add_u32 s43, s43, s40
    s_mul_i32 s54, s3, 15360
    s_add_u32 s3, s22, 4
    s_and_b32 s3, s3, 3
    s_mul_i32 s44, s3, 20480
    s_add_u32 s44, s44, s40
    s_mul_i32 s3, s22, 15360
    v_add_u32 v161, s3, v1
    s_add_u32 s36, s29, s91
    s_add_u32 s36, s36, 10485760
    s_lshl_b32 s3, s24, 18
    s_add_u32 s37, s31, s3
    s_add_u32 s37, s37, 37879808
    s_mov_b32 s3, 0
    s_nop 0
poll_32:
    buffer_load_dword v162, v62, s[4:7], s61 offen offset:0 sc1
    s_add_u32 s3, s3, 1
    s_waitcnt vmcnt(0)
    v_cmp_gt_u32 vcc, s95, v162
    s_cmp_gt_u32 s3, 200000
    s_cbranch_scc1 polld_33
    s_cbranch_vccnz poll_32
    s_nop 1
polld_33:
    s_add_u32 s57, s41, 0
    buffer_load_dwordx4 v[104:107], v1, s[4:7], s57 offen offset:0 sc1
    buffer_load_dwordx4 v[108:111], v1, s[4:7], s57 offen offset:1024 sc1
    buffer_load_dwordx4 v[112:115], v1, s[4:7], s57 offen offset:2048 sc1
    buffer_load_dwordx4 v[116:119], v1, s[4:7], s57 offen offset:3072 sc1
    s_add_u32 s57, s41, 4096
    buffer_load_dwordx4 v[120:123], v1, s[4:7], s57 offen offset:0 sc1
    s_add_u32 s57, s42, 0
    buffer_load_dwordx4 v[124:127], v1, s[4:7], s57 offen offset:0 sc1
    s_waitcnt vmcnt(5)
    v_mfma_f32_16x16x32_bf16 v[64:67], a[0:3], v[104:107], 0
    buffer_load_dwordx4 v[128:131], v1, s[4:7], s57 offen offset:1024 sc1
    v_mfma_f32_16x16x32_bf16 v[68:71], a[4:7], v[104:107], 0
    v_mfma_f32_16x16x32_bf16 v[72:75], a[8:11], v[104:107], 0
    buffer_load_dwordx4 v[132:135], v1, s[4:7], s57 offen offset:2048 sc1
    v_mfma_f32_16x16x32_bf16 v[76:79], a[12:15], v[104:107], 0
    v_mfma_f32_16x16x32_bf16 v[80:83], a[16:19], v[104:107], 0
    buffer_load_dwordx4 v[136:139], v1, s[4:7], s57 offen offset:3072 sc1
    s_waitcnt vmcnt(7)
    v_mfma_f32_16x16x32_bf16 v[64:67], a[20:23], v[108:111], v[64:67]
    s_add_u32 s57, s42, 4096
    buffer_load_dwordx4 v[140:143], v1, s[4:7], s57 offen offset:0 sc1
    v_mfma_f32_16x16x32_bf16 v[68:71], a[24:27], v[108:111], v[68:71]
    v_mfma_f32_16x16x32_bf16 v[72:75], a[28:31], v[108:111], v[72:75]
    s_add_u32 s57, s43, 0
    buffer_load_dwordx4 v[144:147], v1, s[4:7], s57 offen offset:0 sc1
    v_mfma_f32_16x16x32_bf16 v[76:79], a[32:35], v[108:111], v[76:79]
    v_mfma_f32_16x16x32_bf16 v[80:83], a[36:39], v[108:111], v[80:83]
    buffer_load_dwordx4 v[148:151], v1, s[4:7], s57 offen offset:1024 sc1
    s_waitcnt vmcnt(9)
    v_mfma_f32_16x16x32_bf16 v[64:67], a[40:43], v[112:115], v[64:67]
    buffer_load_dwordx4 v[152:155], v1, s[4:7], s57 offen offset:2048 sc1
    v_mfma_f32_16x16x32_bf16 v[68:71], a[44:47], v[112:115], v[68:71]
    v_mfma_f32_16x16x32_bf16 v[72:75], a[48:51], v[112:115], v[72:75]
    buffer_load_dwordx4 v[156:159], v1, s[4:7], s57 offen offset:3072 sc1
    v_mfma_f32_16x16x32_bf16 v[76:79], a[52:55], v[112:115], v[76:79]
    v_mfma_f32_16x16x32_bf16 v[80:83], a[56:59], v[112:115], v[80:83]
    s_add_u32 s57, s43, 4096
    buffer_load_dwordx4 v[104:107], v1, s[4:7], s57 offen offset:0 sc1
    s_waitcnt vmcnt(11)
    v_mfma_f32_16x16x32_bf16 v[64:67], a[60:63], v[116:119], v[64:67]
    s_add_u32 s57, s44, 0
    buffer_load_dwordx4 v[108:111], v1, s[4:7], s57 offen offset:0 sc1
    v_mfma_f32_16x16x32_bf16 v[68:71], a[64:67], v[116:119], v[68:71]
    v_mfma_f32_16x16x32_bf16 v[72:75], a[68:71], v[116:119], v[72:75]
    buffer_load_dwordx4 v[112:115], v1, s[4:7], s57 offen offset:1024 sc1
    v_mfma_f32_16x16x32_bf16 v[76:79], a[72:75], v[116:119], v[76:79]
    v_mfma_f32_16x16x32_bf16 v[80:83], a[76:79], v[116:119], v[80:83]
    buffer_load_dwordx4 v[116:119], v1, s[4:7], s57 offen offset:2048 sc1
    s_waitcnt vmcnt(13)
    v_mfma_f32_16x16x32_bf16 v[64:67], a[80:83], v[120:123], v[64:67]
    v_mfma_f32_16x16x32_bf16 v[68:71], a[84:87], v[120:123], v[68:71]
    v_mfma_f32_16x16x32_bf16 v[72:75], a[88:91], v[120:123], v[72:75]
    v_mfma_f32_16x16x32_bf16 v[76:79], a[92:95], v[120:123], v[76:79]
    buffer_load_dwordx4 a[140:143], v1, s[4:7], s58 offen offset:1024
    v_mfma_f32_16x16x32_bf16 v[80:83], a[96:99], v[120:123], v[80:83]
    buffer_load_dwordx4 v[120:123], v1, s[4:7], s57 offen offset:3072 sc1
    s_waitcnt vmcnt(14)
    v_mfma_f32_16x16x32_bf16 v[84:87], a[0:3], v[124:127], 0
    v_mfma_f32_16x16x32_bf16 v[88:91], a[4:7], v[124:127], 0
    v_mfma_f32_16x16x32_bf16 v[92:95], a[8:11], v[124:127], 0
    v_mfma_f32_16x16x32_bf16 v[96:99], a[12:15], v[124:127], 0
    buffer_load_dwordx4 a[144:147], v1, s[4:7], s58 offen offset:2048
    v_add_u32 v160, s52, v1
    v_mfma_f32_16x16x32_bf16 v[100:103], a[16:19], v[124:127], 0
    s_add_u32 s57, s44, 4096
    buffer_load_dwordx4 v[124:127], v1, s[4:7], s57 offen offset:0 sc1
    s_waitcnt vmcnt(15)
    v_mfma_f32_16x16x32_bf16 v[84:87], a[20:23], v[128:131], v[84:87]
    ds_write_b128 v160, v[64:67] offset:0
    v_mfma_f32_16x16x32_bf16 v[88:91], a[24:27], v[128:131], v[88:91]
    ds_write_b128 v160, v[68:71] offset:1024
    v_mfma_f32_16x16x32_bf16 v[92:95], a[28:31], v[128:131], v[92:95]
    ds_write_b128 v160, v[72:75] offset:2048
    v_mfma_f32_16x16x32_bf16 v[96:99], a[32:35], v[128:131], v[96:99]
    buffer_load_dwordx4 a[148:151], v1, s[4:7], s58 offen offset:3072
    v_mfma_f32_16x16x32_bf16 v[100:103], a[36:39], v[128:131], v[100:103]
    s_add_u32 s58, s88, 36864
    s_waitcnt vmcnt(15)
    v_mfma_f32_16x16x32_bf16 v[84:87], a[40:43], v[132:135], v[84:87]
    ds_write_b128 v160, v[76:79] offset:3072
    v_mfma_f32_16x16x32_bf16 v[88:91], a[44:47], v[132:135], v[88:91]
    ds_write_b128 v160, v[80:83] offset:4096
    v_mfma_f32_16x16x32_bf16 v[92:95], a[48:51], v[132:135], v[92:95]
    buffer_load_dwordx4 a[152:155], v1, s[4:7], s58 offen offset:0
    v_mfma_f32_16x16x32_bf16 v[96:99], a[52:55], v[132:135], v[96:99]
    v_mfma_f32_16x16x32_bf16 v[100:103], a[56:59], v[132:135], v[100:103]
    s_waitcnt vmcnt(15)
    v_mfma_f32_16x16x32_bf16 v[84:87], a[60:63], v[136:139], v[84:87]
    v_mfma_f32_16x16x32_bf16 v[88:91], a[64:67], v[136:139], v[88:91]
    buffer_load_dwordx4 a[156:159], v1, s[4:7], s58 offen offset:1024
    v_mfma_f32_16x16x32_bf16 v[92:95], a[68:71], v[136:139], v[92:95]
    v_mfma_f32_16x16x32_bf16 v[96:99], a[72:75], v[136:139], v[96:99]
    v_mfma_f32_16x16x32_bf16 v[100:103], a[76:79], v[136:139], v[100:103]
    s_waitcnt vmcnt(15)
    v_mfma_f32_16x16x32_bf16 v[84:87], a[80:83], v[140:143], v[84:87]
    buffer_load_dwordx4 a[160:163], v1, s[4:7], s58 offen offset:2048
    v_mfma_f32_16x16x32_bf16 v[88:91], a[84:87], v[140:143], v[88:91]
    v_mfma_f32_16x16x32_bf16 v[92:95], a[88:91], v[140:143], v[92:95]
    v_mfma_f32_16x16x32_bf16 v[96:99], a[92:95], v[140:143], v[96:99]
    v_mfma_f32_16x16x32_bf16 v[100:103], a[96:99], v[140:143], v[100:103]
    buffer_load_dwordx4 a[164:167], v1, s[4:7], s58 offen offset:3072
    s_waitcnt vmcnt(16)
    v_mfma_f32_16x16x32_bf16 v[64:67], a[0:3], v[144:147], 0
    s_add_u32 s58, s89, 0
    v_mfma_f32_16x16x32_bf16 v[68:71], a[4:7], v[144:147], 0
    v_mfma_f32_16x16x32_bf16 v[72:75], a[8:11], v[144:147], 0
    v_mfma_f32_16x16x32_bf16 v[76:79], a[12:15], v[144:147], 0
    buffer_load_dwordx4 a[172:175], v1, s[4:7], s58 offen offset:0
    v_add_u32 v160, s53, v1
    v_mfma_f32_16x16x32_bf16 v[80:83], a[16:19], v[144:147], 0
    ds_write_b128 v160, v[84:87] offset:5120
    s_waitcnt vmcnt(16)
    v_mfma_f32_16x16x32_bf16 v[64:67], a[20:23], v[148:151], v[64:67]
    ds_write_b128 v160, v[88:91] offset:6144
    v_mfma_f32_16x16x32_bf16 v[68:71], a[24:27], v[148:151], v[68:71]
    ds_write_b128 v160, v[92:95] offset:7168
    v_mfma_f32_16x16x32_bf16 v[72:75], a[28:31], v[148:151], v[72:75]
    buffer_load_dwordx4 a[176:179], v1, s[4:7], s58 offen offset:1024
    v_mfma_f32_16x16x32_bf16 v[76:79], a[32:35], v[148:151], v[76:79]
    ds_write_b128 v160, v[96:99] offset:8192
    v_mfma_f32_16x16x32_bf16 v[80:83], a[36:39], v[148:151], v[80:83]
    ds_write_b128 v160, v[100:103] offset:9216
    s_waitcnt vmcnt(16)
    v_mfma_f32_16x16x32_bf16 v[64:67], a[40:43], v[152:155], v[64:67]
    v_mfma_f32_16x16x32_bf16 v[68:71], a[44:47], v[152:155], v[68:71]
    buffer_load_dwordx4 a[180:183], v1, s[4:7], s58 offen offset:2048
    v_mfma_f32_16x16x32_bf16 v[72:75], a[48:51], v[152:155], v[72:75]
    s_waitcnt lgkmcnt(0)
    v_lshlrev_b32 v84, 16, v36
    v_and_b32 v85, 0xffff0000, v36
    v_mfma_f32_16x16x32_bf16 v[76:79], a[52:55], v[152:155], v[76:79]
    v_lshlrev_b32 v86, 16, v37
    v_and_b32 v87, 0xffff0000, v37
    v_mfma_f32_16x16x32_bf16 v[80:83], a[56:59], v[152:155], v[80:83]
    v_lshlrev_b32 v88, 16, v38
    v_and_b32 v89, 0xffff0000, v38
    s_waitcnt vmcnt(16)
    v_mfma_f32_16x16x32_bf16 v[64:67], a[60:63], v[156:159], v[64:67]
    buffer_load_dwordx4 a[184:187], v1, s[4:7], s58 offen offset:3072
    v_lshlrev_b32 v90, 16, v39
    v_mfma_f32_16x16x32_bf16 v[68:71], a[64:67], v[156:159], v[68:71]
    s_add_u32 s58, s89, 4096
    v_and_b32 v91, 0xffff0000, v39
    v_lshlrev_b32 v92, 16, v40
    v_mfma_f32_16x16x32_bf16 v[72:75], a[68:71], v[156:159], v[72:75]
    v_and_b32 v93, 0xffff0000, v40
    v_lshlrev_b32 v94, 16, v41
    v_mfma_f32_16x16x32_bf16 v[76:79], a[72:75], v[156:159], v[76:79]
    v_and_b32 v95, 0xffff0000, v41
    v_lshlrev_b32 v96, 16, v42
    v_mfma_f32_16x16x32_bf16 v[80:83], a[76:79], v[156:159], v[80:83]
    buffer_load_dwordx4 a[188:191], v1, s[4:7], s58 offen offset:0
    v_and_b32 v97, 0xffff0000, v42
    s_waitcnt vmcnt(17)
    v_mfma_f32_16x16x32_bf16 v[64:67], a[80:83], v[104:107], v[64:67]
    v_lshlrev_b32 v98, 16, v43
    v_and_b32 v99, 0xffff0000, v43
    v_mfma_f32_16x16x32_bf16 v[68:71], a[84:87], v[104:107], v[68:71]
    v_lshlrev_b32 v100, 16, v44
    v_and_b32 v101, 0xffff0000, v44
    v_mfma_f32_16x16x32_bf16 v[72:75], a[88:91], v[104:107], v[72:75]
    v_lshlrev_b32 v102, 16, v45
    v_and_b32 v103, 0xffff0000, v45
    v_mfma_f32_16x16x32_bf16 v[76:79], a[92:95], v[104:107], v[76:79]
    buffer_load_dwordx4 a[192:195], v1, s[4:7], s58 offen offset:1024
    v_mfma_f32_16x16x32_bf16 v[80:83], a[96:99], v[104:107], v[80:83]
    s_waitcnt vmcnt(17)
    v_mfma_f32_16x16x32_bf16 v[84:87], a[0:3], v[108:111], v[84:87]
    v_mfma_f32_16x16x32_bf16 v[88:91], a[4:7], v[108:111], v[88:91]
    v_mfma_f32_16x16x32_bf16 v[92:95], a[8:11], v[108:111], v[92:95]
    buffer_load_dwordx4 a[196:199], v1, s[4:7], s58 offen offset:2048
    v_mfma_f32_16x16x32_bf16 v[96:99], a[12:15], v[108:111], v[96:99]
    v_add_u32 v160, s54, v1
    v_mfma_f32_16x16x32_bf16 v[100:103], a[16:19], v[108:111], v[100:103]
    ds_write_b128 v160, v[64:67] offset:10240
    s_waitcnt vmcnt(17)
    v_mfma_f32_16x16x32_bf16 v[84:87], a[20:23], v[112:115], v[84:87]
    ds_write_b128 v160, v[68:71] offset:11264
    v_mfma_f32_16x16x32_bf16 v[88:91], a[24:27], v[112:115], v[88:91]
    ds_write_b128 v160, v[72:75] offset:12288
    v_mfma_f32_16x16x32_bf16 v[92:95], a[28:31], v[112:115], v[92:95]
    ds_write_b128 v160, v[76:79] offset:13312
    v_mfma_f32_16x16x32_bf16 v[96:99], a[32:35], v[112:115], v[96:99]
    ds_write_b128 v160, v[80:83] offset:14336
    v_mfma_f32_16x16x32_bf16 v[100:103], a[36:39], v[112:115], v[100:103]
    s_waitcnt vmcnt(16)
    v_mfma_f32_16x16x32_bf16 v[84:87], a[40:43], v[116:119], v[84:87]
    v_mfma_f32_16x16x32_bf16 v[88:91], a[44:47], v[116:119], v[88:91]
    v_mfma_f32_16x16x32_bf16 v[92:95], a[48:51], v[116:119], v[92:95]
    v_mfma_f32_16x16x32_bf16 v[96:99], a[52:55], v[116:119], v[96:99]
    s_waitcnt lgkmcnt(0)
    s_barrier
    v_mfma_f32_16x16x32_bf16 v[100:103], a[56:59], v[116:119], v[100:103]
    ds_read_b128 v[64:67], v161 offset:0
    s_waitcnt vmcnt(14)
    v_mfma_f32_16x16x32_bf16 v[84:87], a[60:63], v[120:123], v[84:87]
    ds_read_b128 v[68:71], v161 offset:1024
    v_mfma_f32_16x16x32_bf16 v[88:91], a[64:67], v[120:123], v[88:91]
    ds_read_b128 v[72:75], v161 offset:2048
    v_mfma_f32_16x16x32_bf16 v[92:95], a[68:71], v[120:123], v[92:95]
    ds_read_b128 v[76:79], v161 offset:3072
    v_mfma_f32_16x16x32_bf16 v[96:99], a[72:75], v[120:123], v[96:99]
    ds_read_b128 v[80:83], v161 offset:4096
    v_mfma_f32_16x16x32_bf16 v[100:103], a[76:79], v[120:123], v[100:103]
    s_waitcnt vmcnt(12)
    v_mfma_f32_16x16x32_bf16 v[84:87], a[80:83], v[124:127], v[84:87]
    v_mfma_f32_16x16x32_bf16 v[88:91], a[84:87], v[124:127], v[88:91]
    v_mfma_f32_16x16x32_bf16 v[92:95], a[88:91], v[124:127], v[92:95]
    v_mfma_f32_16x16x32_bf16 v[96:99], a[92:95], v[124:127], v[96:99]
    v_mfma_f32_16x16x32_bf16 v[100:103], a[96:99], v[124:127], v[100:103]
    ds_read_b128 v[104:107], v161 offset:5120
    ds_read_b128 v[108:111], v161 offset:6144
    ds_read_b128 v[112:115], v161 offset:7168
    ds_read_b128 v[116:119], v161 offset:8192
    ds_read_b128 v[120:123], v161 offset:9216
    ds_read_b128 v[124:127], v161 offset:10240
    ds_read_b128 v[128:131], v161 offset:11264
    ds_read_b128 v[132:135], v161 offset:12288
    ds_read_b128 v[136:139], v161 offset:13312
    ds_read_b128 v[140:143], v161 offset:14336
    buffer_load_dwordx4 a[200:203], v1, s[4:7], s58 offen offset:3072
    s_add_u32 s58, s89, 8192
    buffer_load_dwordx4 a[204:207], v1, s[4:7], s58 offen offset:0
    buffer_load_dwordx4 a[208:211], v1, s[4:7], s58 offen offset:1024
    buffer_load_dwordx4 a[212:215], v1, s[4:7], s58 offen offset:2048
    v_and_b32 v144, 15, v0
    v_lshlrev_b32 v144, 4, v144
    v_lshrrev_b32 v145, 5, v0
    v_lshl_add_u32 v144, v145, 8, v144
    v_bfe_u32 v145, v0, 4, 1
    v_lshl_add_u32 v144, v145, 3, v144
    v_lshlrev_b32 v145, 3, v0
    v_mov_b32 v146, 0x40000000
    v_cmp_gt_u32 vcc, 16, v0
    s_nop 1
    v_cndmask_b32 v145, v146, v145, vcc
    s_waitcnt lgkmcnt(10)
    v_pk_add_f32 v[84:85], v[84:85], v[64:65]
    v_pk_add_f32 v[86:87], v[86:87], v[66:67]
    v_pk_add_f32 v[88:89], v[88:89], v[68:69]
    v_pk_add_f32 v[90:91], v[90:91], v[70:71]
    v_pk_add_f32 v[92:93], v[92:93], v[72:73]
    v_pk_add_f32 v[94:95], v[94:95], v[74:75]
    v_pk_add_f32 v[96:97], v[96:97], v[76:77]
    v_pk_add_f32 v[98:99], v[98:99], v[78:79]
    v_pk_add_f32 v[100:101], v[100:101], v[80:81]
    v_pk_add_f32 v[102:103], v[102:103], v[82:83]
    s_waitcnt lgkmcnt(5)
    v_pk_add_f32 v[84:85], v[84:85], v[104:105]
    v_pk_add_f32 v[86:87], v[86:87], v[106:107]
    v_pk_add_f32 v[88:89], v[88:89], v[108:109]
    v_pk_add_f32 v[90:91], v[90:91], v[110:111]
    v_pk_add_f32 v[92:93], v[92:93], v[112:113]
    v_pk_add_f32 v[94:95], v[94:95], v[114:115]
    v_pk_add_f32 v[96:97], v[96:97], v[116:117]
    v_pk_add_f32 v[98:99], v[98:99], v[118:119]
    v_pk_add_f32 v[100:101], v[100:101], v[120:121]
    v_pk_add_f32 v[102:103], v[102:103], v[122:123]
    s_waitcnt lgkmcnt(0)
    v_pk_add_f32 v[84:85], v[84:85], v[124:125]
    v_pk_add_f32 v[86:87], v[86:87], v[126:127]
    v_pk_add_f32 v[88:89], v[88:89], v[128:129]
    v_pk_add_f32 v[90:91], v[90:91], v[130:131]
    v_pk_add_f32 v[92:93], v[92:93], v[132:133]
    v_pk_add_f32 v[94:95], v[94:95], v[134:135]
    v_pk_add_f32 v[96:97], v[96:97], v[136:137]
    v_pk_add_f32 v[98:99], v[98:99], v[138:139]
    v_pk_add_f32 v[100:101], v[100:101], v[140:141]
    v_pk_add_f32 v[102:103], v[102:103], v[142:143]
    v_cvt_pk_bf16_f32 v36, v84, v85
    v_cvt_pk_bf16_f32 v37, v86, v87
    v_cvt_pk_bf16_f32 v38, v88, v89
    v_cvt_pk_bf16_f32 v39, v90, v91
    v_cvt_pk_bf16_f32 v40, v92, v93
    v_cvt_pk_bf16_f32 v41, v94, v95
    v_cvt_pk_bf16_f32 v42, v96, v97
    v_cvt_pk_bf16_f32 v43, v98, v99
    v_cvt_pk_bf16_f32 v44, v100, v101
    v_cvt_pk_bf16_f32 v45, v102, v103
    buffer_store_dwordx4 v[36:39], v1, s[4:7], s36 offen sc1
    buffer_store_dwordx4 v[40:43], v1, s[4:7], s36 offen offset:1024 sc1
    buffer_store_dwordx2 v[44:45], v144, s[4:7], s36 offen offset:2048 sc1
    s_mov_b32 s39, 0x3f803f80
    v_dot2_f32_bf16 v64, v36, s39, 0
    v_dot2_f32_bf16 v65, v36, v36, 0
    v_dot2_f32_bf16 v64, v37, s39, v64
    v_dot2_f32_bf16 v65, v37, v37, v65
    v_dot2_f32_bf16 v64, v38, s39, v64
    v_dot2_f32_bf16 v65, v38, v38, v65
    v_dot2_f32_bf16 v64, v39, s39, v64
    v_dot2_f32_bf16 v65, v39, v39, v65
    v_dot2_f32_bf16 v64, v40, s39, v64
    v_dot2_f32_bf16 v65, v40, v40, v65
    v_dot2_f32_bf16 v64, v41, s39, v64
    v_dot2_f32_bf16 v65, v41, v41, v65
    v_dot2_f32_bf16 v64, v42, s39, v64
    v_dot2_f32_bf16 v65, v42, v42, v65
    v_dot2_f32_bf16 v64, v43, s39, v64
    v_dot2_f32_bf16 v65, v43, v43, v65
    v_dot2_f32_bf16 v64, v44, s39, v64
    v_dot2_f32_bf16 v65, v44, v44, v65
    v_dot2_f32_bf16 v64, v45, s39, v64
    v_dot2_f32_bf16 v65, v45, v45, v65
    s_nop 1
    v_mov_b32 v66, v64
    v_mov_b32 v67, v65
    s_nop 0
    v_permlane16_swap_b32 v64, v66
    v_permlane16_swap_b32 v65, v67
    v_pk_add_f32 v[64:65], v[64:65], v[66:67]
    v_mov_b32 v66, v64
    v_mov_b32 v67, v65
    s_nop 0
    v_permlane32_swap_b32 v64, v66
    v_permlane32_swap_b32 v65, v67
    v_pk_add_f32 v[64:65], v[64:65], v[66:67]
    buffer_store_dwordx2 v[64:65], v145, s[4:7], s37 offen sc1
    s_add_u32 s95, s95, 1
    v_mov_b32 v162, s95
    s_mov_b64 exec, 1
    s_cmp_eq_u32 s23, 0
    s_cbranch_scc1 slow_34
    s_waitcnt vmcnt(0)
    buffer_store_dword v162, v63, s[4:7], s60 offen
    s_branch join_35
    s_nop 0
slow_34:
    s_waitcnt vmcnt(0)
    buffer_store_dword v162, v63, s[4:7], s60 offen sc1
    s_nop 1
join_35:
    s_mov_b64 exec, -1
    buffer_load_dwordx4 a[216:219], v1, s[4:7], s58 offen offset:3072
    s_add_u32 s58, s89, 12288
    buffer_load_dwordx4 a[220:223], v1, s[4:7], s58 offen offset:0
    buffer_load_dwordx4 a[224:227], v1, s[4:7], s58 offen offset:1024
    buffer_load_dwordx4 a[228:231], v1, s[4:7], s58 offen offset:2048
    buffer_load_dwordx4 a[232:235], v1, s[4:7], s58 offen offset:3072
    s_add_u32 s58, s89, 16384
    buffer_load_dwordx4 a[236:239], v1, s[4:7], s58 offen offset:0
    buffer_load_dwordx4 a[240:243], v1, s[4:7], s58 offen offset:1024
    buffer_load_dwordx4 a[244:247], v1, s[4:7], s58 offen offset:2048
    s_mul_i32 s44, s22, 5120
    s_mul_i32 s45, s20, 163840
    s_add_u32 s45, s45, s91
    s_lshr_b32 s50, s22, 1
    s_and_b32 s51, s22, 1
    s_mul_i32 s51, s51, 5120
    s_mul_i32 s46, s50, 20480
    s_add_u32 s46, s46, s45
    s_add_u32 s46, s46, 10485760
    s_add_u32 s46, s46, s51
    s_add_u32 s45, s45, s44
    v_lshrrev_b32 v104, 4, v0
    s_lshl_b32 s3, s22, 2
    v_add_u32 v104, s3, v104
    v_and_b32 v105, 15, v0
    v_lshlrev_b32 v151, 3, v105
    v_lshl_add_u32 v107, v104, 10, v151
    v_add_u32 v151, 162048, v151
    v_min_u32 v158, 11, v104
    v_lshl_add_u32 v158, v158, 7, v151
    s_lshl_b32 s40, s20, 13
    s_lshl_b32 s3, s24, 18
    s_add_u32 s40, s40, s3
    s_add_u32 s40, s40, 37879808
    v_mov_b32 v108, s40
    v_mov_b32 v109, 0x40000000
    v_cmp_gt_u32 vcc, 8, v104
    s_nop 1
    v_cndmask_b32 v108, v109, v108, vcc
    v_add_u32 v107, v107, v108
    v_mov_b32 v148, v1
    v_add_u32 v149, 61440, v1
    s_lshl_b32 s41, s20, 3
    s_mul_i32 s41, s41, 54
    s_add_u32 s41, s41, s92
    s_lshl_b32 s41, s41, 10
    s_mul_i32 s3, s24, 7077888
    s_add_u32 s41, s41, s3
    s_add_u32 s41, s41, 23592960
    s_mov_b32 s42, 0xbacccccd
    s_mov_b32 s43, 0x3727c5ac
    s_cmp_lg_u32 s24, 0
    s_cbranch_scc1 p0_36
    v_mov_b32 v136, 0x3f803f80
    v_mov_b32 v137, 0x3f803f80
    v_mov_b32 v138, 0x3f803f80
    v_mov_b32 v139, 0x3f803f80
    v_and_b32 v25, 0xffff0000, v21
    v_lshlrev_b32 v24, 16, v21
    v_and_b32 v23, 0xffff0000, v20
    v_lshlrev_b32 v22, 16, v20
    v_and_b32 v21, 0xffff0000, v19
    v_lshlrev_b32 v20, 16, v19
    v_and_b32 v19, 0xffff0000, v18
    v_lshlrev_b32 v18, 16, v18
    v_mfma_f32_16x16x32_bf16 v[140:143], v[168:171], v[136:139], 0
    v_mfma_f32_16x16x32_bf16 v[144:147], v[172:175], v[136:139], 0
    v_mfma_f32_16x16x32_bf16 v[140:143], v[176:179], v[136:139], v[140:143]
    v_mfma_f32_16x16x32_bf16 v[144:147], v[180:183], v[136:139], v[144:147]
    v_mfma_f32_16x16x32_bf16 v[140:143], v[184:187], v[136:139], v[140:143]
    v_mfma_f32_16x16x32_bf16 v[144:147], v[188:191], v[136:139], v[144:147]
    v_mfma_f32_16x16x32_bf16 v[140:143], v[192:195], v[136:139], v[140:143]
    v_mfma_f32_16x16x32_bf16 v[144:147], v[196:199], v[136:139], v[144:147]
    v_mfma_f32_16x16x32_bf16 v[140:143], v[200:203], v[136:139], v[140:143]
    v_mfma_f32_16x16x32_bf16 v[144:147], v[204:207], v[136:139], v[144:147]
    v_mfma_f32_16x16x32_bf16 v[140:143], v[208:211], v[136:139], v[140:143]
    v_mfma_f32_16x16x32_bf16 v[144:147], v[212:215], v[136:139], v[144:147]
    v_mfma_f32_16x16x32_bf16 v[140:143], v[216:219], v[136:139], v[140:143]
    v_mfma_f32_16x16x32_bf16 v[144:147], v[220:223], v[136:139], v[144:147]
    v_mfma_f32_16x16x32_bf16 v[140:143], v[224:227], v[136:139], v[140:143]
    v_mfma_f32_16x16x32_bf16 v[144:147], v[228:231], v[136:139], v[144:147]
    v_mfma_f32_16x16x32_bf16 v[140:143], v[232:235], v[136:139], v[140:143]
    v_mfma_f32_16x16x32_bf16 v[144:147], v[236:239], v[136:139], v[144:147]
    v_mfma_f32_16x16x32_bf16 v[140:143], v[240:243], v[136:139], v[140:143]
    v_mfma_f32_16x16x32_bf16 v[144:147], v[244:247], v[136:139], v[144:147]
    v_mfma_f32_16x16x32_bf16 v[140:143], v[248:251], v[136:139], v[140:143]
    v_mfma_f32_16x16x32_bf16 v[144:147], v[252:255], v[136:139], v[144:147]
    v_mfma_f32_16x16x32_bf16 v[140:143], a[168:171], v[136:139], v[140:143]
    v_mfma_f32_16x16x32_bf16 v[144:147], a[100:103], v[136:139], v[144:147]
    v_mfma_f32_16x16x32_bf16 v[140:143], a[104:107], v[136:139], v[140:143]
    v_mfma_f32_16x16x32_bf16 v[144:147], a[108:111], v[136:139], v[144:147]
    v_mfma_f32_16x16x32_bf16 v[140:143], a[112:115], v[136:139], v[140:143]
    v_mfma_f32_16x16x32_bf16 v[144:147], a[116:119], v[136:139], v[144:147]
    v_mfma_f32_16x16x32_bf16 v[140:143], a[120:123], v[136:139], v[140:143]
    v_mfma_f32_16x16x32_bf16 v[144:147], a[124:127], v[136:139], v[144:147]
    v_mfma_f32_16x16x32_bf16 v[140:143], a[128:131], v[136:139], v[140:143]
    v_mfma_f32_16x16x32_bf16 v[144:147], a[132:135], v[136:139], v[144:147]
    v_mfma_f32_16x16x32_bf16 v[140:143], a[136:139], v[136:139], v[140:143]
    v_mfma_f32_16x16x32_bf16 v[144:147], a[140:143], v[136:139], v[144:147]
    v_mfma_f32_16x16x32_bf16 v[140:143], a[144:147], v[136:139], v[140:143]
    v_mfma_f32_16x16x32_bf16 v[144:147], a[148:151], v[136:139], v[144:147]
    v_mfma_f32_16x16x32_bf16 v[140:143], a[152:155], v[136:139], v[140:143]
    v_mfma_f32_16x16x32_bf16 v[144:147], a[156:159], v[136:139], v[144:147]
    v_mfma_f32_16x16x32_bf16 v[140:143], a[160:163], v[136:139], v[140:143]
    v_mfma_f32_16x16x32_bf16 v[144:147], a[164:167], v[136:139], v[144:147]
    s_nop 6
    v_mov_b32 v10, v140
    v_mov_b32 v11, v141
    v_mov_b32 v12, v142
    v_mov_b32 v13, v143
    v_mov_b32 v14, v144
    v_mov_b32 v15, v145
    v_mov_b32 v16, v146
    v_mov_b32 v17, v147
    s_nop 4
p0_36:
    s_mov_b32 s3, 0
    s_nop 0
poll_37:
    buffer_load_dword v162, v62, s[4:7], s61 offen offset:0 sc1
    s_add_u32 s3, s3, 1
    s_waitcnt vmcnt(0)
    v_cmp_gt_u32 vcc, s95, v162
    s_cmp_gt_u32 s3, 200000
    s_cbranch_scc1 polld_38
    s_cbranch_vccnz poll_37
    s_nop 1
polld_38:
    s_cmp_ge_u32 s21, 14
    s_cbranch_scc1 p3_skip_39
    s_add_u32 m0, s44, 0
    s_add_u32 s57, s46, 0
    buffer_load_dwordx4 v1, s[4:7], s57 offen offset:0 sc1 lds
    buffer_load_dwordx4 v1, s[4:7], s57 offen offset:1024 sc1 lds
    buffer_load_dwordx4 v1, s[4:7], s57 offen offset:2048 sc1 lds
    buffer_load_dwordx4 v1, s[4:7], s57 offen offset:3072 sc1 lds
    s_add_u32 m0, s44, 4096
    s_add_u32 s57, s46, 4096
    buffer_load_dwordx4 v1, s[4:7], s57 offen offset:0 sc1 lds
    v_mov_b32 v159, v107
    buffer_load_dwordx2 v[96:97], v159, s[4:7], 0 offen offset:0 sc1
    buffer_load_dwordx2 v[98:99], v159, s[4:7], 0 offen offset:128 sc1
    buffer_load_dwordx2 v[100:101], v159, s[4:7], 0 offen offset:256 sc1
    buffer_load_dwordx2 v[102:103], v159, s[4:7], 0 offen offset:384 sc1
    buffer_load_dwordx2 v[140:141], v159, s[4:7], 0 offen offset:512 sc1
    buffer_load_dwordx2 v[142:143], v159, s[4:7], 0 offen offset:640 sc1
    buffer_load_dwordx2 v[144:145], v159, s[4:7], 0 offen offset:768 sc1
    buffer_load_dwordx2 v[146:147], v159, s[4:7], 0 offen offset:896 sc1
    s_add_u32 m0, s44, 20480
    s_add_u32 s57, s46, 10240
    buffer_load_dwordx4 v1, s[4:7], s57 offen offset:0 sc1 lds
    buffer_load_dwordx4 v1, s[4:7], s57 offen offset:1024 sc1 lds
    buffer_load_dwordx4 v1, s[4:7], s57 offen offset:2048 sc1 lds
    buffer_load_dwordx4 v1, s[4:7], s57 offen offset:3072 sc1 lds
    s_add_u32 m0, s44, 24576
    s_add_u32 s57, s46, 14336
    buffer_load_dwordx4 v1, s[4:7], s57 offen offset:0 sc1 lds
    s_waitcnt vmcnt(13)
    s_waitcnt lgkmcnt(0)
    s_barrier
    ds_read_b128 v[104:107], v148 offset:0
    ds_read_b128 v[108:111], v148 offset:10240
    ds_read_b128 v[112:115], v148 offset:1024
    ds_read_b128 v[116:119], v148 offset:11264
    ds_read_b128 v[120:123], v148 offset:2048
    ds_read_b128 v[124:127], v148 offset:12288
    s_waitcnt lgkmcnt(4)
    v_mfma_f32_16x16x32_bf16 v[64:67], v[168:171], v[104:107], 0
    ds_read_b128 v[128:131], v148 offset:3072
    s_add_u32 m0, s44, 40960
    v_mfma_f32_16x16x32_bf16 v[68:71], v[172:175], v[104:107], 0
    s_add_u32 s57, s45, 10526720
    buffer_load_dwordx4 v1, s[4:7], s57 offen offset:0 sc1 lds
    v_mfma_f32_16x16x32_bf16 v[72:75], v[168:171], v[108:111], 0
    ds_read_b128 v[132:135], v148 offset:13312
    v_mfma_f32_16x16x32_bf16 v[76:79], v[172:175], v[108:111], 0
    s_waitcnt lgkmcnt(4)
    v_mfma_f32_16x16x32_bf16 v[64:67], v[176:179], v[112:115], v[64:67]
    ds_read_b128 v[104:107], v148 offset:4096
    s_waitcnt vmcnt(6)
    v_mfma_f32_16x16x32_bf16 v[68:71], v[180:183], v[112:115], v[68:71]
    buffer_load_dwordx4 v1, s[4:7], s57 offen offset:1024 sc1 lds
    v_add_f32 v96, v96, v140
    v_mfma_f32_16x16x32_bf16 v[72:75], v[176:179], v[116:119], v[72:75]
    ds_read_b128 v[108:111], v148 offset:14336
    v_add_f32 v97, v97, v141
    v_mfma_f32_16x16x32_bf16 v[76:79], v[180:183], v[116:119], v[76:79]
    s_waitcnt lgkmcnt(4)
    v_add_f32 v98, v98, v142
    v_add_f32 v99, v99, v143
    v_mfma_f32_16x16x32_bf16 v[64:67], v[184:187], v[120:123], v[64:67]
    ds_read_b128 v[112:115], v148 offset:5120
    v_add_f32 v100, v100, v144
    v_mfma_f32_16x16x32_bf16 v[68:71], v[188:191], v[120:123], v[68:71]
    buffer_load_dwordx4 v1, s[4:7], s57 offen offset:2048 sc1 lds
    v_add_f32 v101, v101, v145
    v_mfma_f32_16x16x32_bf16 v[72:75], v[184:187], v[124:127], v[72:75]
    ds_read_b128 v[116:119], v148 offset:15360
    v_add_f32 v102, v102, v146
    v_mfma_f32_16x16x32_bf16 v[76:79], v[188:191], v[124:127], v[76:79]
    s_waitcnt lgkmcnt(4)
    v_add_f32 v103, v103, v147
    v_add_f32 v96, v96, v100
    v_mfma_f32_16x16x32_bf16 v[64:67], v[192:195], v[128:131], v[64:67]
    ds_read_b128 v[120:123], v148 offset:6144
    v_add_f32 v97, v97, v101
    v_mfma_f32_16x16x32_bf16 v[68:71], v[196:199], v[128:131], v[68:71]
    buffer_load_dwordx4 v1, s[4:7], s57 offen offset:3072 sc1 lds
    v_add_f32 v98, v98, v102
    v_mfma_f32_16x16x32_bf16 v[72:75], v[192:195], v[132:135], v[72:75]
    ds_read_b128 v[124:127], v148 offset:16384
    s_add_u32 m0, s44, 45056
    v_mfma_f32_16x16x32_bf16 v[76:79], v[196:199], v[132:135], v[76:79]
    s_add_u32 s57, s45, 10530816
    v_add_f32 v99, v99, v103
    s_waitcnt lgkmcnt(4)
    v_mfma_f32_16x16x32_bf16 v[64:67], v[200:203], v[104:107], v[64:67]
    ds_read_b128 v[128:131], v148 offset:7168
    v_add_f32 v96, v96, v98
    v_mfma_f32_16x16x32_bf16 v[68:71], v[204:207], v[104:107], v[68:71]
    buffer_load_dwordx4 v1, s[4:7], s57 offen offset:0 sc1 lds
    v_add_f32 v97, v97, v99
    v_mfma_f32_16x16x32_bf16 v[72:75], v[200:203], v[108:111], v[72:75]
    ds_read_b128 v[132:135], v148 offset:17408
    s_add_u32 m0, s44, 61440
    v_mfma_f32_16x16x32_bf16 v[76:79], v[204:207], v[108:111], v[76:79]
    s_add_u32 s57, s45, 10547200
    v_mul_f32 v96, s42, v96
    s_waitcnt lgkmcnt(4)
    v_mfma_f32_16x16x32_bf16 v[64:67], v[208:211], v[112:115], v[64:67]
    ds_read_b128 v[104:107], v148 offset:8192
    v_mul_f32 v97, s42, v97
    v_mfma_f32_16x16x32_bf16 v[68:71], v[212:215], v[112:115], v[68:71]
    buffer_load_dwordx4 v1, s[4:7], s57 offen offset:0 sc1 lds
    v_fma_f32 v97, v96, v96, v97
    v_mfma_f32_16x16x32_bf16 v[72:75], v[208:211], v[116:119], v[72:75]
    ds_read_b128 v[108:111], v148 offset:18432
    v_min_f32 v97, 0, v97
    v_mfma_f32_16x16x32_bf16 v[76:79], v[212:215], v[116:119], v[76:79]
    s_waitcnt lgkmcnt(4)
    v_cvt_pk_bf16_f32 v97, v96, v97
    v_lshlrev_b32 v96, 16, v97
    v_mfma_f32_16x16x32_bf16 v[64:67], v[216:219], v[120:123], v[64:67]
    ds_read_b128 v[112:115], v148 offset:9216
    v_and_b32 v97, 0xffff0000, v97
    v_mfma_f32_16x16x32_bf16 v[68:71], v[220:223], v[120:123], v[68:71]
    buffer_load_dwordx4 v1, s[4:7], s57 offen offset:1024 sc1 lds
    v_sub_f32 v97, s43, v97
    v_mfma_f32_16x16x32_bf16 v[72:75], v[216:219], v[124:127], v[72:75]
    ds_read_b128 v[116:119], v148 offset:19456
    v_cvt_pk_bf16_f32 v97, 0, v97
    v_mfma_f32_16x16x32_bf16 v[76:79], v[220:223], v[124:127], v[76:79]
    s_waitcnt lgkmcnt(4)
    v_sqrt_f32 v97, v97
    s_nop 0
    v_cvt_pk_bf16_f32 v97, 0, v97
    v_rcp_f32 v97, v97
    s_nop 0
    ds_write_b64 v158, v[96:97]
    s_waitcnt lgkmcnt(0)
    s_waitcnt vmcnt(7)
    s_barrier
    v_mfma_f32_16x16x32_bf16 v[64:67], v[224:227], v[128:131], v[64:67]
    ds_read_b128 v[120:123], v148 offset:20480
    v_mfma_f32_16x16x32_bf16 v[68:71], v[228:231], v[128:131], v[68:71]
    buffer_load_dwordx4 v1, s[4:7], s57 offen offset:2048 sc1 lds
    v_mfma_f32_16x16x32_bf16 v[72:75], v[224:227], v[132:135], v[72:75]
    ds_read_b128 v[124:127], v148 offset:30720
    v_mfma_f32_16x16x32_bf16 v[76:79], v[228:231], v[132:135], v[76:79]
    v_mfma_f32_16x16x32_bf16 v[64:67], v[232:235], v[104:107], v[64:67]
    ds_read_b128 v[128:131], v148 offset:21504
    v_mfma_f32_16x16x32_bf16 v[68:71], v[236:239], v[104:107], v[68:71]
    buffer_load_dwordx4 v1, s[4:7], s57 offen offset:3072 sc1 lds
    v_mfma_f32_16x16x32_bf16 v[72:75], v[232:235], v[108:111], v[72:75]
    ds_read_b128 v[132:135], v148 offset:31744
    s_add_u32 m0, s44, 65536
    v_mfma_f32_16x16x32_bf16 v[76:79], v[236:239], v[108:111], v[76:79]
    s_add_u32 s57, s45, 10551296
    v_mfma_f32_16x16x32_bf16 v[64:67], v[240:243], v[112:115], v[64:67]
    ds_read_b128 v[104:107], v148 offset:22528
    v_mfma_f32_16x16x32_bf16 v[68:71], v[244:247], v[112:115], v[68:71]
    buffer_load_dwordx4 v1, s[4:7], s57 offen offset:0 sc1 lds
    v_mfma_f32_16x16x32_bf16 v[72:75], v[240:243], v[116:119], v[72:75]
    ds_read_b128 v[108:111], v148 offset:32768
    s_add_u32 m0, s44, 81920
    v_mfma_f32_16x16x32_bf16 v[76:79], v[244:247], v[116:119], v[76:79]
    s_add_u32 s57, s45, 10567680
    s_waitcnt lgkmcnt(4)
    v_mfma_f32_16x16x32_bf16 v[64:67], v[248:251], v[120:123], v[64:67]
    ds_read_b128 v[112:115], v148 offset:23552
    v_mfma_f32_16x16x32_bf16 v[68:71], v[252:255], v[120:123], v[68:71]
    buffer_load_dwordx4 v1, s[4:7], s57 offen offset:0 sc1 lds
    v_mfma_f32_16x16x32_bf16 v[72:75], v[248:251], v[124:127], v[72:75]
    ds_read_b128 v[116:119], v148 offset:33792
    v_mfma_f32_16x16x32_bf16 v[76:79], v[252:255], v[124:127], v[76:79]
    s_waitcnt lgkmcnt(4)
    v_mfma_f32_16x16x32_bf16 v[64:67], a[168:171], v[128:131], v[64:67]
    ds_read_b128 v[120:123], v148 offset:24576
    v_mfma_f32_16x16x32_bf16 v[68:71], a[100:103], v[128:131], v[68:71]
    buffer_load_dwordx4 v1, s[4:7], s57 offen offset:1024 sc1 lds
    v_mfma_f32_16x16x32_bf16 v[72:75], a[168:171], v[132:135], v[72:75]
    ds_read_b128 v[124:127], v148 offset:34816
    v_mfma_f32_16x16x32_bf16 v[76:79], a[100:103], v[132:135], v[76:79]
    s_waitcnt lgkmcnt(4)
    v_mfma_f32_16x16x32_bf16 v[64:67], a[104:107], v[104:107], v[64:67]
    ds_read_b128 v[128:131], v148 offset:25600
    v_mfma_f32_16x16x32_bf16 v[68:71], a[108:111], v[104:107], v[68:71]
    buffer_load_dwordx4 v1, s[4:7], s57 offen offset:2048 sc1 lds
    v_mfma_f32_16x16x32_bf16 v[72:75], a[104:107], v[108:111], v[72:75]
    ds_read_b128 v[132:135], v148 offset:35840
    v_mfma_f32_16x16x32_bf16 v[76:79], a[108:111], v[108:111], v[76:79]
    s_waitcnt lgkmcnt(4)
    v_mfma_f32_16x16x32_bf16 v[64:67], a[112:115], v[112:115], v[64:67]
    ds_read_b128 v[104:107], v148 offset:26624
    v_mfma_f32_16x16x32_bf16 v[68:71], a[116:119], v[112:115], v[68:71]
    buffer_load_dwordx4 v1, s[4:7], s57 offen offset:3072 sc1 lds
    v_mfma_f32_16x16x32_bf16 v[72:75], a[112:115], v[116:119], v[72:75]
    ds_read_b128 v[108:111], v148 offset:36864
    s_add_u32 m0, s44, 86016
    v_mfma_f32_16x16x32_bf16 v[76:79], a[116:119], v[116:119], v[76:79]
    s_add_u32 s57, s45, 10571776
    s_waitcnt lgkmcnt(4)
    v_mfma_f32_16x16x32_bf16 v[64:67], a[120:123], v[120:123], v[64:67]
    ds_read_b128 v[112:115], v148 offset:27648
    v_mfma_f32_16x16x32_bf16 v[68:71], a[124:127], v[120:123], v[68:71]
    buffer_load_dwordx4 v1, s[4:7], s57 offen offset:0 sc1 lds
    v_mfma_f32_16x16x32_bf16 v[72:75], a[120:123], v[124:127], v[72:75]
    ds_read_b128 v[116:119], v148 offset:37888
    s_add_u32 s58, s89, 16384
    v_mfma_f32_16x16x32_bf16 v[76:79], a[124:127], v[124:127], v[76:79]
    s_waitcnt lgkmcnt(4)
    v_mfma_f32_16x16x32_bf16 v[64:67], a[128:131], v[128:131], v[64:67]
    ds_read_b128 v[120:123], v148 offset:28672
    v_mfma_f32_16x16x32_bf16 v[68:71], a[132:135], v[128:131], v[68:71]
    buffer_load_dwordx4 a[248:251], v1, s[4:7], s58 offen offset:3072
    v_mfma_f32_16x16x32_bf16 v[72:75], a[128:131], v[132:135], v[72:75]
    ds_read_b128 v[124:127], v148 offset:38912
    s_add_u32 s58, s89, 20480
    v_mfma_f32_16x16x32_bf16 v[76:79], a[132:135], v[132:135], v[76:79]
    s_waitcnt lgkmcnt(4)
    v_mfma_f32_16x16x32_bf16 v[64:67], a[136:139], v[104:107], v[64:67]
    ds_read_b128 v[128:131], v148 offset:29696
    v_mfma_f32_16x16x32_bf16 v[68:71], a[140:143], v[104:107], v[68:71]
    buffer_load_dwordx4 a[252:255], v1, s[4:7], s58 offen offset:0
    v_mfma_f32_16x16x32_bf16 v[72:75], a[136:139], v[108:111], v[72:75]
    ds_read_b128 v[132:135], v148 offset:39936
    v_mfma_f32_16x16x32_bf16 v[76:79], a[140:143], v[108:111], v[76:79]
    s_waitcnt lgkmcnt(4)
    s_waitcnt vmcnt(12)
    s_barrier
    v_mfma_f32_16x16x32_bf16 v[64:67], a[144:147], v[112:115], v[64:67]
    ds_read_b128 v[104:107], v148 offset:40960
    s_add_u32 m0, s44, 102400
    v_mfma_f32_16x16x32_bf16 v[68:71], a[148:151], v[112:115], v[68:71]
    s_add_u32 s57, s45, 10588160
    buffer_load_dwordx4 v1, s[4:7], s57 offen offset:0 sc1 lds
    v_mfma_f32_16x16x32_bf16 v[72:75], a[144:147], v[116:119], v[72:75]
    ds_read_b128 v[108:111], v148 offset:41984
    v_mfma_f32_16x16x32_bf16 v[76:79], a[148:151], v[116:119], v[76:79]
    s_waitcnt lgkmcnt(4)
    v_mfma_f32_16x16x32_bf16 v[64:67], a[152:155], v[120:123], v[64:67]
    ds_read_b128 v[112:115], v148 offset:43008
    v_mfma_f32_16x16x32_bf16 v[68:71], a[156:159], v[120:123], v[68:71]
    buffer_load_dwordx4 v1, s[4:7], s57 offen offset:1024 sc1 lds
    v_mfma_f32_16x16x32_bf16 v[72:75], a[152:155], v[124:127], v[72:75]
    ds_read_b128 v[116:119], v148 offset:44032
    v_mfma_f32_16x16x32_bf16 v[76:79], a[156:159], v[124:127], v[76:79]
    s_waitcnt lgkmcnt(4)
    v_mfma_f32_16x16x32_bf16 v[64:67], a[160:163], v[128:131], v[64:67]
    ds_read_b128 v[120:123], v148 offset:45056
    v_mfma_f32_16x16x32_bf16 v[68:71], a[164:167], v[128:131], v[68:71]
    buffer_load_dwordx4 v1, s[4:7], s57 offen offset:2048 sc1 lds
    v_mfma_f32_16x16x32_bf16 v[72:75], a[160:163], v[132:135], v[72:75]
    ds_read_b128 v[124:127], v148 offset:46080
    v_mfma_f32_16x16x32_bf16 v[76:79], a[164:167], v[132:135], v[76:79]
    s_waitcnt lgkmcnt(4)
    ds_read_b64 v[136:137], v151 offset:0
    ds_read_b64 v[138:139], v151 offset:128
    v_mfma_f32_16x16x32_bf16 v[80:83], v[168:171], v[104:107], 0
    ds_read_b128 v[128:131], v148 offset:47104
    v_mfma_f32_16x16x32_bf16 v[84:87], v[172:175], v[104:107], 0
    buffer_load_dwordx4 v1, s[4:7], s57 offen offset:3072 sc1 lds
    v_mfma_f32_16x16x32_bf16 v[80:83], v[176:179], v[108:111], v[80:83]
    ds_read_b128 v[132:135], v148 offset:48128
    s_add_u32 m0, s44, 106496
    v_mfma_f32_16x16x32_bf16 v[84:87], v[180:183], v[108:111], v[84:87]
    s_add_u32 s57, s45, 10592256
    s_waitcnt lgkmcnt(6)
    v_mfma_f32_16x16x32_bf16 v[80:83], v[184:187], v[112:115], v[80:83]
    ds_read_b128 v[104:107], v148 offset:49152
    v_mfma_f32_16x16x32_bf16 v[84:87], v[188:191], v[112:115], v[84:87]
    buffer_load_dwordx4 v1, s[4:7], s57 offen offset:0 sc1 lds
    v_mfma_f32_16x16x32_bf16 v[80:83], v[192:195], v[116:119], v[80:83]
    ds_read_b128 v[108:111], v148 offset:50176
    v_mfma_f32_16x16x32_bf16 v[84:87], v[196:199], v[116:119], v[84:87]
    s_waitcnt lgkmcnt(6)
    v_mfma_f32_16x16x32_bf16 v[80:83], v[200:203], v[120:123], v[80:83]
    ds_read_b128 v[112:115], v148 offset:51200
    s_add_u32 s56, s41, 0
    v_mfma_f32_16x16x32_bf16 v[84:87], v[204:207], v[120:123], v[84:87]
    buffer_load_dwordx4 v[164:167], v1, s[4:7], s58 offen offset:1024
    s_waitcnt lgkmcnt(6)
    v_mfma_f32_16x16x32_bf16 v[80:83], v[208:211], v[124:127], v[80:83]
    ds_read_b128 v[116:119], v148 offset:52224
    v_fmac_f32 v64, v136, v10
    v_mfma_f32_16x16x32_bf16 v[84:87], v[212:215], v[124:127], v[84:87]
    s_waitcnt lgkmcnt(4)
    v_fmac_f32 v65, v136, v11
    v_fmac_f32 v66, v136, v12
    v_mfma_f32_16x16x32_bf16 v[80:83], v[216:219], v[128:131], v[80:83]
    ds_read_b128 v[120:123], v148 offset:53248
    v_fmac_f32 v67, v136, v13
    v_mfma_f32_16x16x32_bf16 v[84:87], v[220:223], v[128:131], v[84:87]
    buffer_load_dwordx4 a[0:3], v1, s[4:7], s58 offen offset:2048
    v_fmac_f32 v68, v136, v14
    v_mfma_f32_16x16x32_bf16 v[80:83], v[224:227], v[132:135], v[80:83]
    ds_read_b128 v[124:127], v148 offset:54272
    v_fmac_f32 v69, v136, v15
    v_mfma_f32_16x16x32_bf16 v[84:87], v[228:231], v[132:135], v[84:87]
    s_waitcnt lgkmcnt(4)
    v_fmac_f32 v70, v136, v16
    v_fmac_f32 v71, v136, v17
    v_mfma_f32_16x16x32_bf16 v[80:83], v[232:235], v[104:107], v[80:83]
    ds_read_b128 v[128:131], v148 offset:55296
    v_fma_f32 v64, v64, v137, v18
    v_mfma_f32_16x16x32_bf16 v[84:87], v[236:239], v[104:107], v[84:87]
    buffer_load_dwordx4 a[4:7], v1, s[4:7], s58 offen offset:3072
    v_fma_f32 v65, v65, v137, v19
    v_mfma_f32_16x16x32_bf16 v[80:83], v[240:243], v[108:111], v[80:83]
    ds_read_b128 v[132:135], v148 offset:56320
    s_add_u32 s58, s89, 24576
    v_mfma_f32_16x16x32_bf16 v[84:87], v[244:247], v[108:111], v[84:87]
    s_waitcnt lgkmcnt(4)
    v_fma_f32 v66, v66, v137, v20
    v_fma_f32 v67, v67, v137, v21
    v_mfma_f32_16x16x32_bf16 v[80:83], v[248:251], v[112:115], v[80:83]
    ds_read_b128 v[104:107], v148 offset:57344
    v_fma_f32 v68, v68, v137, v22
    v_mfma_f32_16x16x32_bf16 v[84:87], v[252:255], v[112:115], v[84:87]
    buffer_load_dwordx4 a[8:11], v1, s[4:7], s58 offen offset:0
    v_fma_f32 v69, v69, v137, v23
    v_mfma_f32_16x16x32_bf16 v[80:83], a[168:171], v[116:119], v[80:83]
    ds_read_b128 v[108:111], v148 offset:58368
    v_fma_f32 v70, v70, v137, v24
    v_mfma_f32_16x16x32_bf16 v[84:87], a[100:103], v[116:119], v[84:87]
    s_waitcnt lgkmcnt(4)
    v_fma_f32 v71, v71, v137, v25
    v_max_f32 v64, 0, v64
    v_mfma_f32_16x16x32_bf16 v[80:83], a[104:107], v[120:123], v[80:83]
    ds_read_b128 v[112:115], v148 offset:59392
    v_max_f32 v65, 0, v65
    v_mfma_f32_16x16x32_bf16 v[84:87], a[108:111], v[120:123], v[84:87]
    buffer_load_dwordx4 a[12:15], v1, s[4:7], s58 offen offset:1024
    v_max_f32 v66, 0, v66
    v_mfma_f32_16x16x32_bf16 v[80:83], a[112:115], v[124:127], v[80:83]
    ds_read_b128 v[116:119], v148 offset:60416
    v_max_f32 v67, 0, v67
    v_mfma_f32_16x16x32_bf16 v[84:87], a[116:119], v[124:127], v[84:87]
    s_waitcnt lgkmcnt(4)
    v_max_f32 v68, 0, v68
    v_max_f32 v69, 0, v69
    s_waitcnt vmcnt(17)
    s_barrier
    v_mfma_f32_16x16x32_bf16 v[80:83], a[120:123], v[128:131], v[80:83]
    ds_read_b128 v[120:123], v149 offset:0
    s_add_u32 m0, s44, 0
    v_mfma_f32_16x16x32_bf16 v[84:87], a[124:127], v[128:131], v[84:87]
    s_add_u32 s57, s45, 10608640
    buffer_load_dwordx4 v1, s[4:7], s57 offen offset:0 sc1 lds
    v_mfma_f32_16x16x32_bf16 v[80:83], a[128:131], v[132:135], v[80:83]
    ds_read_b128 v[124:127], v149 offset:1024
    v_max_f32 v70, 0, v70
    v_mfma_f32_16x16x32_bf16 v[84:87], a[132:135], v[132:135], v[84:87]
    s_waitcnt lgkmcnt(4)
    v_max_f32 v71, 0, v71
    v_mul_f32 v64, v64, v64
    v_mfma_f32_16x16x32_bf16 v[80:83], a[136:139], v[104:107], v[80:83]
    ds_read_b128 v[128:131], v149 offset:2048
    v_mul_f32 v65, v65, v65
    v_mfma_f32_16x16x32_bf16 v[84:87], a[140:143], v[104:107], v[84:87]
    buffer_load_dwordx4 v1, s[4:7], s57 offen offset:1024 sc1 lds
    v_mul_f32 v66, v66, v66
    v_mfma_f32_16x16x32_bf16 v[80:83], a[144:147], v[108:111], v[80:83]
    ds_read_b128 v[132:135], v149 offset:3072
    v_mul_f32 v67, v67, v67
    v_mfma_f32_16x16x32_bf16 v[84:87], a[148:151], v[108:111], v[84:87]
    s_waitcnt lgkmcnt(4)
    v_mul_f32 v68, v68, v68
    v_mul_f32 v69, v69, v69
    v_mfma_f32_16x16x32_bf16 v[80:83], a[152:155], v[112:115], v[80:83]
    ds_read_b128 v[104:107], v149 offset:4096
    v_mul_f32 v70, v70, v70
    v_mfma_f32_16x16x32_bf16 v[84:87], a[156:159], v[112:115], v[84:87]
    buffer_load_dwordx4 v1, s[4:7], s57 offen offset:2048 sc1 lds
    v_mul_f32 v71, v71, v71
    v_mfma_f32_16x16x32_bf16 v[80:83], a[160:163], v[116:119], v[80:83]
    ds_read_b128 v[108:111], v149 offset:5120
    v_mfma_f32_16x16x32_bf16 v[84:87], a[164:167], v[116:119], v[84:87]
    ds_read_b64 v[136:137], v151 offset:256
    s_waitcnt lgkmcnt(5)
    v_cvt_pk_bf16_f32 v140, v64, v65
    v_cvt_pk_bf16_f32 v141, v66, v67
    v_cvt_pk_bf16_f32 v142, v68, v69
    v_cvt_pk_bf16_f32 v143, v70, v71
    buffer_store_dwordx4 v[140:143], v1, s[4:7], s56 offen sc1
    v_mfma_f32_16x16x32_bf16 v[64:67], v[168:171], v[120:123], 0
    ds_read_b128 v[112:115], v149 offset:6144
    s_add_u32 s56, s41, 55296
    v_mfma_f32_16x16x32_bf16 v[68:71], v[172:175], v[120:123], 0
    buffer_load_dwordx4 v1, s[4:7], s57 offen offset:3072 sc1 lds
    v_mfma_f32_16x16x32_bf16 v[64:67], v[176:179], v[124:127], v[64:67]
    ds_read_b128 v[116:119], v149 offset:7168
    s_add_u32 m0, s44, 4096
    v_mfma_f32_16x16x32_bf16 v[68:71], v[180:183], v[124:127], v[68:71]
    s_add_u32 s57, s45, 10612736
    v_fmac_f32 v72, v138, v10
    s_waitcnt lgkmcnt(5)
    v_mfma_f32_16x16x32_bf16 v[64:67], v[184:187], v[128:131], v[64:67]
    ds_read_b128 v[120:123], v149 offset:8192
    v_fmac_f32 v73, v138, v11
    v_mfma_f32_16x16x32_bf16 v[68:71], v[188:191], v[128:131], v[68:71]
    buffer_load_dwordx4 v1, s[4:7], s57 offen offset:0 sc1 lds
    v_fmac_f32 v74, v138, v12
    v_mfma_f32_16x16x32_bf16 v[64:67], v[192:195], v[132:135], v[64:67]
    ds_read_b128 v[124:127], v149 offset:9216
    v_fmac_f32 v75, v138, v13
    v_mfma_f32_16x16x32_bf16 v[68:71], v[196:199], v[132:135], v[68:71]
    s_waitcnt lgkmcnt(5)
    v_fmac_f32 v76, v138, v14
    v_fmac_f32 v77, v138, v15
    v_mfma_f32_16x16x32_bf16 v[64:67], v[200:203], v[104:107], v[64:67]
    ds_read_b128 v[128:131], v149 offset:10240
    v_fmac_f32 v78, v138, v16
    v_mfma_f32_16x16x32_bf16 v[68:71], v[204:207], v[104:107], v[68:71]
    buffer_load_dwordx4 a[16:19], v1, s[4:7], s58 offen offset:2048
    v_fmac_f32 v79, v138, v17
    v_mfma_f32_16x16x32_bf16 v[64:67], v[208:211], v[108:111], v[64:67]
    ds_read_b128 v[132:135], v149 offset:11264
    v_fma_f32 v72, v72, v139, v18
    v_mfma_f32_16x16x32_bf16 v[68:71], v[212:215], v[108:111], v[68:71]
    s_waitcnt lgkmcnt(4)
    v_fma_f32 v73, v73, v139, v19
    v_fma_f32 v74, v74, v139, v20
    v_mfma_f32_16x16x32_bf16 v[64:67], v[216:219], v[112:115], v[64:67]
    ds_read_b128 v[104:107], v149 offset:12288
    v_fma_f32 v75, v75, v139, v21
    v_mfma_f32_16x16x32_bf16 v[68:71], v[220:223], v[112:115], v[68:71]
    buffer_load_dwordx4 a[20:23], v1, s[4:7], s58 offen offset:3072
    v_fma_f32 v76, v76, v139, v22
    v_mfma_f32_16x16x32_bf16 v[64:67], v[224:227], v[116:119], v[64:67]
    ds_read_b128 v[108:111], v149 offset:13312
    s_add_u32 s58, s89, 28672
    v_mfma_f32_16x16x32_bf16 v[68:71], v[228:231], v[116:119], v[68:71]
    s_waitcnt lgkmcnt(4)
    v_fma_f32 v77, v77, v139, v23
    v_fma_f32 v78, v78, v139, v24
    v_mfma_f32_16x16x32_bf16 v[64:67], v[232:235], v[120:123], v[64:67]
    ds_read_b128 v[112:115], v149 offset:14336
    v_fma_f32 v79, v79, v139, v25
    v_mfma_f32_16x16x32_bf16 v[68:71], v[236:239], v[120:123], v[68:71]
    buffer_load_dwordx4 a[24:27], v1, s[4:7], s58 offen offset:0
    v_max_f32 v72, 0, v72
    v_mfma_f32_16x16x32_bf16 v[64:67], v[240:243], v[124:127], v[64:67]
    ds_read_b128 v[116:119], v149 offset:15360
    v_max_f32 v73, 0, v73
    v_mfma_f32_16x16x32_bf16 v[68:71], v[244:247], v[124:127], v[68:71]
    s_waitcnt lgkmcnt(4)
    v_max_f32 v74, 0, v74
    v_max_f32 v75, 0, v75
    v_mfma_f32_16x16x32_bf16 v[64:67], v[248:251], v[128:131], v[64:67]
    ds_read_b128 v[120:123], v149 offset:16384
    v_max_f32 v76, 0, v76
    v_mfma_f32_16x16x32_bf16 v[68:71], v[252:255], v[128:131], v[68:71]
    buffer_load_dwordx4 a[28:31], v1, s[4:7], s58 offen offset:1024
    v_max_f32 v77, 0, v77
    v_mfma_f32_16x16x32_bf16 v[64:67], a[168:171], v[132:135], v[64:67]
    ds_read_b128 v[124:127], v149 offset:17408
    v_max_f32 v78, 0, v78
    v_mfma_f32_16x16x32_bf16 v[68:71], a[100:103], v[132:135], v[68:71]
    s_waitcnt lgkmcnt(4)
    v_max_f32 v79, 0, v79
    v_mul_f32 v72, v72, v72
    v_mfma_f32_16x16x32_bf16 v[64:67], a[104:107], v[104:107], v[64:67]
    ds_read_b128 v[128:131], v149 offset:18432
    v_mul_f32 v73, v73, v73
    v_mfma_f32_16x16x32_bf16 v[68:71], a[108:111], v[104:107], v[68:71]
    buffer_load_dwordx4 a[32:35], v1, s[4:7], s58 offen offset:2048
    v_mul_f32 v74, v74, v74
    v_mfma_f32_16x16x32_bf16 v[64:67], a[112:115], v[108:111], v[64:67]
    ds_read_b128 v[132:135], v149 offset:19456
    v_mul_f32 v75, v75, v75
    v_mfma_f32_16x16x32_bf16 v[68:71], a[116:119], v[108:111], v[68:71]
    s_waitcnt lgkmcnt(4)
    v_mul_f32 v76, v76, v76
    v_mul_f32 v77, v77, v77
    s_waitcnt vmcnt(23)
    s_barrier
    v_mfma_f32_16x16x32_bf16 v[64:67], a[120:123], v[112:115], v[64:67]
    ds_read_b128 v[104:107], v149 offset:20480
    s_add_u32 m0, s44, 20480
    v_mfma_f32_16x16x32_bf16 v[68:71], a[124:127], v[112:115], v[68:71]
    s_add_u32 s57, s45, 10629120
    buffer_load_dwordx4 v1, s[4:7], s57 offen offset:0 sc1 lds
    v_mfma_f32_16x16x32_bf16 v[64:67], a[128:131], v[116:119], v[64:67]
    ds_read_b128 v[108:111], v149 offset:21504
    v_mul_f32 v78, v78, v78
    v_mfma_f32_16x16x32_bf16 v[68:71], a[132:135], v[116:119], v[68:71]
    s_waitcnt lgkmcnt(4)
    v_mul_f32 v79, v79, v79
    v_mfma_f32_16x16x32_bf16 v[64:67], a[136:139], v[120:123], v[64:67]
    ds_read_b128 v[112:115], v149 offset:22528
    v_mfma_f32_16x16x32_bf16 v[68:71], a[140:143], v[120:123], v[68:71]
    buffer_load_dwordx4 v1, s[4:7], s57 offen offset:1024 sc1 lds
    v_mfma_f32_16x16x32_bf16 v[64:67], a[144:147], v[124:127], v[64:67]
    ds_read_b128 v[116:119], v149 offset:23552
    v_mfma_f32_16x16x32_bf16 v[68:71], a[148:151], v[124:127], v[68:71]
    ds_read_b64 v[138:139], v151 offset:384
    s_waitcnt lgkmcnt(5)
    v_mfma_f32_16x16x32_bf16 v[64:67], a[152:155], v[128:131], v[64:67]
    ds_read_b128 v[120:123], v149 offset:24576
    v_cvt_pk_bf16_f32 v144, v72, v73
    v_mfma_f32_16x16x32_bf16 v[68:71], a[156:159], v[128:131], v[68:71]
    buffer_load_dwordx4 v1, s[4:7], s57 offen offset:2048 sc1 lds
    v_cvt_pk_bf16_f32 v145, v74, v75
    v_mfma_f32_16x16x32_bf16 v[64:67], a[160:163], v[132:135], v[64:67]
    ds_read_b128 v[124:127], v149 offset:25600
    v_cvt_pk_bf16_f32 v146, v76, v77
    v_mfma_f32_16x16x32_bf16 v[68:71], a[164:167], v[132:135], v[68:71]
    s_waitcnt lgkmcnt(5)
    v_cvt_pk_bf16_f32 v147, v78, v79
    buffer_store_dwordx4 v[144:147], v1, s[4:7], s56 offen sc1
    v_mfma_f32_16x16x32_bf16 v[72:75], v[168:171], v[104:107], 0
    ds_read_b128 v[128:131], v149 offset:26624
    s_add_u32 s56, s41, 110592
    v_mfma_f32_16x16x32_bf16 v[76:79], v[172:175], v[104:107], 0
    buffer_load_dwordx4 v1, s[4:7], s57 offen offset:3072 sc1 lds
    v_mfma_f32_16x16x32_bf16 v[72:75], v[176:179], v[108:111], v[72:75]
    ds_read_b128 v[132:135], v149 offset:27648
    s_add_u32 m0, s44, 24576
    v_mfma_f32_16x16x32_bf16 v[76:79], v[180:183], v[108:111], v[76:79]
    s_add_u32 s57, s45, 10633216
    v_fmac_f32 v80, v136, v10
    s_waitcnt lgkmcnt(5)
    v_mfma_f32_16x16x32_bf16 v[72:75], v[184:187], v[112:115], v[72:75]
    ds_read_b128 v[104:107], v149 offset:28672
    v_fmac_f32 v81, v136, v11
    v_mfma_f32_16x16x32_bf16 v[76:79], v[188:191], v[112:115], v[76:79]
    buffer_load_dwordx4 v1, s[4:7], s57 offen offset:0 sc1 lds
    v_fmac_f32 v82, v136, v12
    v_mfma_f32_16x16x32_bf16 v[72:75], v[192:195], v[116:119], v[72:75]
    ds_read_b128 v[108:111], v149 offset:29696
    v_fmac_f32 v83, v136, v13
    v_mfma_f32_16x16x32_bf16 v[76:79], v[196:199], v[116:119], v[76:79]
    s_waitcnt lgkmcnt(4)
    v_fmac_f32 v84, v136, v14
    v_fmac_f32 v85, v136, v15
    v_mfma_f32_16x16x32_bf16 v[72:75], v[200:203], v[120:123], v[72:75]
    ds_read_b128 v[112:115], v149 offset:30720
    v_fmac_f32 v86, v136, v16
    v_mfma_f32_16x16x32_bf16 v[76:79], v[204:207], v[120:123], v[76:79]
    buffer_load_dwordx4 a[36:39], v1, s[4:7], s58 offen offset:3072
    v_fmac_f32 v87, v136, v17
    v_mfma_f32_16x16x32_bf16 v[72:75], v[208:211], v[124:127], v[72:75]
    ds_read_b128 v[116:119], v149 offset:31744
    s_add_u32 s58, s89, 32768
    v_mfma_f32_16x16x32_bf16 v[76:79], v[212:215], v[124:127], v[76:79]
    s_waitcnt lgkmcnt(4)
    v_fma_f32 v80, v80, v137, v18
    v_fma_f32 v81, v81, v137, v19
    v_mfma_f32_16x16x32_bf16 v[72:75], v[216:219], v[128:131], v[72:75]
    ds_read_b128 v[120:123], v149 offset:32768
    v_fma_f32 v82, v82, v137, v20
    v_mfma_f32_16x16x32_bf16 v[76:79], v[220:223], v[128:131], v[76:79]
    buffer_load_dwordx4 a[40:43], v1, s[4:7], s58 offen offset:0
    v_fma_f32 v83, v83, v137, v21
    v_mfma_f32_16x16x32_bf16 v[72:75], v[224:227], v[132:135], v[72:75]
    ds_read_b128 v[124:127], v149 offset:33792
    v_fma_f32 v84, v84, v137, v22
    v_mfma_f32_16x16x32_bf16 v[76:79], v[228:231], v[132:135], v[76:79]
    s_waitcnt lgkmcnt(4)
    v_fma_f32 v85, v85, v137, v23
    v_fma_f32 v86, v86, v137, v24
    v_mfma_f32_16x16x32_bf16 v[72:75], v[232:235], v[104:107], v[72:75]
    ds_read_b128 v[128:131], v149 offset:34816
    v_fma_f32 v87, v87, v137, v25
    v_mfma_f32_16x16x32_bf16 v[76:79], v[236:239], v[104:107], v[76:79]
    buffer_load_dwordx4 a[44:47], v1, s[4:7], s58 offen offset:1024
    v_max_f32 v80, 0, v80
    v_mfma_f32_16x16x32_bf16 v[72:75], v[240:243], v[108:111], v[72:75]
    ds_read_b128 v[132:135], v149 offset:35840
    v_max_f32 v81, 0, v81
    v_mfma_f32_16x16x32_bf16 v[76:79], v[244:247], v[108:111], v[76:79]
    s_waitcnt lgkmcnt(4)
    v_max_f32 v82, 0, v82
    v_max_f32 v83, 0, v83
    v_mfma_f32_16x16x32_bf16 v[72:75], v[248:251], v[112:115], v[72:75]
    ds_read_b128 v[104:107], v149 offset:36864
    v_max_f32 v84, 0, v84
    v_mfma_f32_16x16x32_bf16 v[76:79], v[252:255], v[112:115], v[76:79]
    buffer_load_dwordx4 a[48:51], v1, s[4:7], s58 offen offset:2048
    v_max_f32 v85, 0, v85
    v_mfma_f32_16x16x32_bf16 v[72:75], a[168:171], v[116:119], v[72:75]
    ds_read_b128 v[108:111], v149 offset:37888
    v_max_f32 v86, 0, v86
    v_mfma_f32_16x16x32_bf16 v[76:79], a[100:103], v[116:119], v[76:79]
    s_waitcnt lgkmcnt(4)
    v_max_f32 v87, 0, v87
    v_mul_f32 v80, v80, v80
    v_mfma_f32_16x16x32_bf16 v[72:75], a[104:107], v[120:123], v[72:75]
    ds_read_b128 v[112:115], v149 offset:38912
    v_mul_f32 v81, v81, v81
    v_mfma_f32_16x16x32_bf16 v[76:79], a[108:111], v[120:123], v[76:79]
    buffer_load_dwordx4 a[52:55], v1, s[4:7], s58 offen offset:3072
    v_mul_f32 v82, v82, v82
    v_mfma_f32_16x16x32_bf16 v[72:75], a[112:115], v[124:127], v[72:75]
    ds_read_b128 v[116:119], v149 offset:39936
    s_add_u32 s58, s89, 36864
    v_mfma_f32_16x16x32_bf16 v[76:79], a[116:119], v[124:127], v[76:79]
    s_waitcnt lgkmcnt(4)
    v_mul_f32 v83, v83, v83
    v_mul_f32 v84, v84, v84
    s_waitcnt vmcnt(27)
    s_barrier
    v_mfma_f32_16x16x32_bf16 v[72:75], a[120:123], v[128:131], v[72:75]
    ds_read_b128 v[120:123], v149 offset:40960
    v_mul_f32 v85, v85, v85
    v_mfma_f32_16x16x32_bf16 v[76:79], a[124:127], v[128:131], v[76:79]
    buffer_load_dwordx4 a[56:59], v1, s[4:7], s58 offen offset:0
    v_mul_f32 v86, v86, v86
    v_mfma_f32_16x16x32_bf16 v[72:75], a[128:131], v[132:135], v[72:75]
    ds_read_b128 v[124:127], v149 offset:41984
    v_mul_f32 v87, v87, v87
    v_mfma_f32_16x16x32_bf16 v[76:79], a[132:135], v[132:135], v[76:79]
    ds_read_b64 v[136:137], v151 offset:512
    s_waitcnt lgkmcnt(5)
    v_mfma_f32_16x16x32_bf16 v[72:75], a[136:139], v[104:107], v[72:75]
    ds_read_b128 v[128:131], v149 offset:43008
    v_cvt_pk_bf16_f32 v140, v80, v81
    v_mfma_f32_16x16x32_bf16 v[76:79], a[140:143], v[104:107], v[76:79]
    buffer_load_dwordx4 a[60:63], v1, s[4:7], s58 offen offset:1024
    v_cvt_pk_bf16_f32 v141, v82, v83
    v_mfma_f32_16x16x32_bf16 v[72:75], a[144:147], v[108:111], v[72:75]
    ds_read_b128 v[132:135], v149 offset:44032
    v_cvt_pk_bf16_f32 v142, v84, v85
    v_mfma_f32_16x16x32_bf16 v[76:79], a[148:151], v[108:111], v[76:79]
    s_waitcnt lgkmcnt(5)
    v_cvt_pk_bf16_f32 v143, v86, v87
    v_mfma_f32_16x16x32_bf16 v[72:75], a[152:155], v[112:115], v[72:75]
    ds_read_b128 v[104:107], v149 offset:45056
    v_mfma_f32_16x16x32_bf16 v[76:79], a[156:159], v[112:115], v[76:79]
    buffer_load_dwordx4 a[64:67], v1, s[4:7], s58 offen offset:2048
    v_mfma_f32_16x16x32_bf16 v[72:75], a[160:163], v[116:119], v[72:75]
    ds_read_b128 v[108:111], v149 offset:46080
    v_mfma_f32_16x16x32_bf16 v[76:79], a[164:167], v[116:119], v[76:79]
    buffer_store_dwordx4 v[140:143], v1, s[4:7], s56 offen sc1
    s_waitcnt lgkmcnt(5)
    v_mfma_f32_16x16x32_bf16 v[80:83], v[168:171], v[120:123], 0
    ds_read_b128 v[112:115], v149 offset:47104
    s_add_u32 s56, s41, 165888
    v_mfma_f32_16x16x32_bf16 v[84:87], v[172:175], v[120:123], 0
    v_fmac_f32 v64, v138, v10
    v_fmac_f32 v65, v138, v11
    v_mfma_f32_16x16x32_bf16 v[80:83], v[176:179], v[124:127], v[80:83]
    ds_read_b128 v[116:119], v149 offset:48128
    v_fmac_f32 v66, v138, v12
    v_mfma_f32_16x16x32_bf16 v[84:87], v[180:183], v[124:127], v[84:87]
    buffer_load_dwordx4 a[68:71], v1, s[4:7], s58 offen offset:3072
    s_waitcnt lgkmcnt(4)
    v_mfma_f32_16x16x32_bf16 v[80:83], v[184:187], v[128:131], v[80:83]
    ds_read_b128 v[120:123], v149 offset:49152
    s_add_u32 s58, s89, 40960
    v_mfma_f32_16x16x32_bf16 v[84:87], v[188:191], v[128:131], v[84:87]
    v_fmac_f32 v67, v138, v13
    v_fmac_f32 v68, v138, v14
    v_mfma_f32_16x16x32_bf16 v[80:83], v[192:195], v[132:135], v[80:83]
    ds_read_b128 v[124:127], v149 offset:50176
    v_fmac_f32 v69, v138, v15
    v_mfma_f32_16x16x32_bf16 v[84:87], v[196:199], v[132:135], v[84:87]
    buffer_load_dwordx4 a[72:75], v1, s[4:7], s58 offen offset:0
    s_waitcnt lgkmcnt(4)
    v_mfma_f32_16x16x32_bf16 v[80:83], v[200:203], v[104:107], v[80:83]
    ds_read_b128 v[128:131], v149 offset:51200
    v_fmac_f32 v70, v138, v16
    v_mfma_f32_16x16x32_bf16 v[84:87], v[204:207], v[104:107], v[84:87]
    v_fmac_f32 v71, v138, v17
    v_fma_f32 v64, v64, v139, v18
    v_mfma_f32_16x16x32_bf16 v[80:83], v[208:211], v[108:111], v[80:83]
    ds_read_b128 v[132:135], v149 offset:52224
    v_fma_f32 v65, v65, v139, v19
    v_mfma_f32_16x16x32_bf16 v[84:87], v[212:215], v[108:111], v[84:87]
    buffer_load_dwordx4 a[76:79], v1, s[4:7], s58 offen offset:1024
    s_waitcnt lgkmcnt(4)
    v_mfma_f32_16x16x32_bf16 v[80:83], v[216:219], v[112:115], v[80:83]
    ds_read_b128 v[104:107], v149 offset:53248
    v_fma_f32 v66, v66, v139, v20
    v_mfma_f32_16x16x32_bf16 v[84:87], v[220:223], v[112:115], v[84:87]
    v_fma_f32 v67, v67, v139, v21
    v_fma_f32 v68, v68, v139, v22
    v_mfma_f32_16x16x32_bf16 v[80:83], v[224:227], v[116:119], v[80:83]
    ds_read_b128 v[108:111], v149 offset:54272
    v_fma_f32 v69, v69, v139, v23
    v_mfma_f32_16x16x32_bf16 v[84:87], v[228:231], v[116:119], v[84:87]
    buffer_load_dwordx4 a[80:83], v1, s[4:7], s58 offen offset:2048
    s_waitcnt lgkmcnt(4)
    v_mfma_f32_16x16x32_bf16 v[80:83], v[232:235], v[120:123], v[80:83]
    ds_read_b128 v[112:115], v149 offset:55296
    v_fma_f32 v70, v70, v139, v24
    v_mfma_f32_16x16x32_bf16 v[84:87], v[236:239], v[120:123], v[84:87]
    v_fma_f32 v71, v71, v139, v25
    v_max_f32 v64, 0, v64
    v_mfma_f32_16x16x32_bf16 v[80:83], v[240:243], v[124:127], v[80:83]
    ds_read_b128 v[116:119], v149 offset:56320
    v_max_f32 v65, 0, v65
    v_mfma_f32_16x16x32_bf16 v[84:87], v[244:247], v[124:127], v[84:87]
    buffer_load_dwordx4 a[84:87], v1, s[4:7], s58 offen offset:3072
    s_waitcnt lgkmcnt(4)
    v_mfma_f32_16x16x32_bf16 v[80:83], v[248:251], v[128:131], v[80:83]
    ds_read_b128 v[120:123], v149 offset:57344
    s_add_u32 s58, s89, 45056
    v_mfma_f32_16x16x32_bf16 v[84:87], v[252:255], v[128:131], v[84:87]
    v_max_f32 v66, 0, v66
    v_max_f32 v67, 0, v67
    v_mfma_f32_16x16x32_bf16 v[80:83], a[168:171], v[132:135], v[80:83]
    ds_read_b128 v[124:127], v149 offset:58368
    v_max_f32 v68, 0, v68
    v_mfma_f32_16x16x32_bf16 v[84:87], a[100:103], v[132:135], v[84:87]
    buffer_load_dwordx4 a[88:91], v1, s[4:7], s58 offen offset:0
    s_waitcnt lgkmcnt(4)
    v_mfma_f32_16x16x32_bf16 v[80:83], a[104:107], v[104:107], v[80:83]
    ds_read_b128 v[128:131], v149 offset:59392
    v_max_f32 v69, 0, v69
    v_mfma_f32_16x16x32_bf16 v[84:87], a[108:111], v[104:107], v[84:87]
    v_max_f32 v70, 0, v70
    v_max_f32 v71, 0, v71
    v_mfma_f32_16x16x32_bf16 v[80:83], a[112:115], v[108:111], v[80:83]
    ds_read_b128 v[132:135], v149 offset:60416
    v_mul_f32 v64, v64, v64
    v_mfma_f32_16x16x32_bf16 v[84:87], a[116:119], v[108:111], v[84:87]
    buffer_load_dwordx4 a[92:95], v1, s[4:7], s58 offen offset:1024
    s_waitcnt lgkmcnt(4)
    s_waitcnt vmcnt(27)
    s_barrier
    v_mfma_f32_16x16x32_bf16 v[80:83], a[120:123], v[112:115], v[80:83]
    ds_read_b128 v[104:107], v148 offset:0
    v_mul_f32 v65, v65, v65
    v_mfma_f32_16x16x32_bf16 v[84:87], a[124:127], v[112:115], v[84:87]
    v_mul_f32 v66, v66, v66
    v_mul_f32 v67, v67, v67
    v_mfma_f32_16x16x32_bf16 v[80:83], a[128:131], v[116:119], v[80:83]
    ds_read_b128 v[108:111], v148 offset:1024
    v_mul_f32 v68, v68, v68
    v_mfma_f32_16x16x32_bf16 v[84:87], a[132:135], v[116:119], v[84:87]
    buffer_load_dwordx4 a[96:99], v1, s[4:7], s58 offen offset:2048
    s_waitcnt lgkmcnt(4)
    v_mfma_f32_16x16x32_bf16 v[80:83], a[136:139], v[120:123], v[80:83]
    ds_read_b128 v[112:115], v148 offset:2048
    v_mul_f32 v69, v69, v69
    v_mfma_f32_16x16x32_bf16 v[84:87], a[140:143], v[120:123], v[84:87]
    v_mul_f32 v70, v70, v70
    v_mul_f32 v71, v71, v71
    v_mfma_f32_16x16x32_bf16 v[80:83], a[144:147], v[124:127], v[80:83]
    ds_read_b128 v[116:119], v148 offset:3072
    v_mfma_f32_16x16x32_bf16 v[84:87], a[148:151], v[124:127], v[84:87]
    ds_read_b64 v[138:139], v151 offset:640
    s_waitcnt lgkmcnt(5)
    v_mfma_f32_16x16x32_bf16 v[80:83], a[152:155], v[128:131], v[80:83]
    ds_read_b128 v[120:123], v148 offset:4096
    v_cvt_pk_bf16_f32 v144, v64, v65
    v_mfma_f32_16x16x32_bf16 v[84:87], a[156:159], v[128:131], v[84:87]
    v_cvt_pk_bf16_f32 v145, v66, v67
    v_cvt_pk_bf16_f32 v146, v68, v69
    v_mfma_f32_16x16x32_bf16 v[80:83], a[160:163], v[132:135], v[80:83]
    ds_read_b128 v[124:127], v148 offset:5120
    v_cvt_pk_bf16_f32 v147, v70, v71
    v_mfma_f32_16x16x32_bf16 v[84:87], a[164:167], v[132:135], v[84:87]
    buffer_store_dwordx4 v[144:147], v1, s[4:7], s56 offen sc1
    s_waitcnt lgkmcnt(5)
    v_mfma_f32_16x16x32_bf16 v[64:67], v[168:171], v[104:107], 0
    ds_read_b128 v[128:131], v148 offset:6144
    s_add_u32 s56, s41, 221184
    v_mfma_f32_16x16x32_bf16 v[68:71], v[172:175], v[104:107], 0
    v_fmac_f32 v72, v136, v10
    v_fmac_f32 v73, v136, v11
    v_mfma_f32_16x16x32_bf16 v[64:67], v[176:179], v[108:111], v[64:67]
    ds_read_b128 v[132:135], v148 offset:7168
    v_fmac_f32 v74, v136, v12
    v_mfma_f32_16x16x32_bf16 v[68:71], v[180:183], v[108:111], v[68:71]
    s_waitcnt lgkmcnt(5)
    v_fmac_f32 v75, v136, v13
    v_fmac_f32 v76, v136, v14
    v_mfma_f32_16x16x32_bf16 v[64:67], v[184:187], v[112:115], v[64:67]
    ds_read_b128 v[104:107], v148 offset:8192
    v_fmac_f32 v77, v136, v15
    v_mfma_f32_16x16x32_bf16 v[68:71], v[188:191], v[112:115], v[68:71]
    v_fmac_f32 v78, v136, v16
    v_fmac_f32 v79, v136, v17
    v_mfma_f32_16x16x32_bf16 v[64:67], v[192:195], v[116:119], v[64:67]
    ds_read_b128 v[108:111], v148 offset:9216
    v_fma_f32 v72, v72, v137, v18
    v_mfma_f32_16x16x32_bf16 v[68:71], v[196:199], v[116:119], v[68:71]
    s_waitcnt lgkmcnt(4)
    v_fma_f32 v73, v73, v137, v19
    v_fma_f32 v74, v74, v137, v20
    v_mfma_f32_16x16x32_bf16 v[64:67], v[200:203], v[120:123], v[64:67]
    ds_read_b128 v[112:115], v148 offset:10240
    v_fma_f32 v75, v75, v137, v21
    v_mfma_f32_16x16x32_bf16 v[68:71], v[204:207], v[120:123], v[68:71]
    v_fma_f32 v76, v76, v137, v22
    v_fma_f32 v77, v77, v137, v23
    v_mfma_f32_16x16x32_bf16 v[64:67], v[208:211], v[124:127], v[64:67]
    ds_read_b128 v[116:119], v148 offset:11264
    v_fma_f32 v78, v78, v137, v24
    v_mfma_f32_16x16x32_bf16 v[68:71], v[212:215], v[124:127], v[68:71]
    s_waitcnt lgkmcnt(4)
    v_fma_f32 v79, v79, v137, v25
    v_max_f32 v72, 0, v72
    v_mfma_f32_16x16x32_bf16 v[64:67], v[216:219], v[128:131], v[64:67]
    ds_read_b128 v[120:123], v148 offset:12288
    v_max_f32 v73, 0, v73
    v_mfma_f32_16x16x32_bf16 v[68:71], v[220:223], v[128:131], v[68:71]
    v_max_f32 v74, 0, v74
    v_max_f32 v75, 0, v75
    v_mfma_f32_16x16x32_bf16 v[64:67], v[224:227], v[132:135], v[64:67]
    ds_read_b128 v[124:127], v148 offset:13312
    v_max_f32 v76, 0, v76
    v_mfma_f32_16x16x32_bf16 v[68:71], v[228:231], v[132:135], v[68:71]
    s_waitcnt lgkmcnt(4)
    v_max_f32 v77, 0, v77
    v_max_f32 v78, 0, v78
    v_mfma_f32_16x16x32_bf16 v[64:67], v[232:235], v[104:107], v[64:67]
    ds_read_b128 v[128:131], v148 offset:14336
    v_max_f32 v79, 0, v79
    v_mfma_f32_16x16x32_bf16 v[68:71], v[236:239], v[104:107], v[68:71]
    v_mul_f32 v72, v72, v72
    v_mul_f32 v73, v73, v73
    v_mfma_f32_16x16x32_bf16 v[64:67], v[240:243], v[108:111], v[64:67]
    ds_read_b128 v[132:135], v148 offset:15360
    v_mul_f32 v74, v74, v74
    v_mfma_f32_16x16x32_bf16 v[68:71], v[244:247], v[108:111], v[68:71]
    s_waitcnt lgkmcnt(4)
    v_mul_f32 v75, v75, v75
    v_mul_f32 v76, v76, v76
    v_mfma_f32_16x16x32_bf16 v[64:67], v[248:251], v[112:115], v[64:67]
    ds_read_b128 v[104:107], v148 offset:16384
    v_mul_f32 v77, v77, v77
    v_mfma_f32_16x16x32_bf16 v[68:71], v[252:255], v[112:115], v[68:71]
    v_mul_f32 v78, v78, v78
    v_mul_f32 v79, v79, v79
    v_mfma_f32_16x16x32_bf16 v[64:67], a[168:171], v[116:119], v[64:67]
    ds_read_b128 v[108:111], v148 offset:17408
    v_mfma_f32_16x16x32_bf16 v[68:71], a[100:103], v[116:119], v[68:71]
    ds_read_b64 v[136:137], v151 offset:768
    s_waitcnt lgkmcnt(5)
    v_mfma_f32_16x16x32_bf16 v[64:67], a[104:107], v[120:123], v[64:67]
    ds_read_b128 v[112:115], v148 offset:18432
    v_cvt_pk_bf16_f32 v140, v72, v73
    v_mfma_f32_16x16x32_bf16 v[68:71], a[108:111], v[120:123], v[68:71]
    v_cvt_pk_bf16_f32 v141, v74, v75
    v_cvt_pk_bf16_f32 v142, v76, v77
    v_mfma_f32_16x16x32_bf16 v[64:67], a[112:115], v[124:127], v[64:67]
    ds_read_b128 v[116:119], v148 offset:19456
    v_cvt_pk_bf16_f32 v143, v78, v79
    v_mfma_f32_16x16x32_bf16 v[68:71], a[116:119], v[124:127], v[68:71]
    buffer_store_dwordx4 v[140:143], v1, s[4:7], s56 offen sc1
    s_waitcnt lgkmcnt(5)
    s_waitcnt vmcnt(19)
    s_barrier
    v_mfma_f32_16x16x32_bf16 v[64:67], a[120:123], v[128:131], v[64:67]
    ds_read_b128 v[120:123], v148 offset:20480
    s_add_u32 s56, s41, 276480
    v_mfma_f32_16x16x32_bf16 v[68:71], a[124:127], v[128:131], v[68:71]
    v_fmac_f32 v80, v138, v10
    v_fmac_f32 v81, v138, v11
    v_mfma_f32_16x16x32_bf16 v[64:67], a[128:131], v[132:135], v[64:67]
    ds_read_b128 v[124:127], v148 offset:21504
    v_fmac_f32 v82, v138, v12
    v_mfma_f32_16x16x32_bf16 v[68:71], a[132:135], v[132:135], v[68:71]
    s_waitcnt lgkmcnt(5)
    v_fmac_f32 v83, v138, v13
    v_fmac_f32 v84, v138, v14
    v_mfma_f32_16x16x32_bf16 v[64:67], a[136:139], v[104:107], v[64:67]
    ds_read_b128 v[128:131], v148 offset:22528
    v_fmac_f32 v85, v138, v15
    v_mfma_f32_16x16x32_bf16 v[68:71], a[140:143], v[104:107], v[68:71]
    v_fmac_f32 v86, v138, v16
    v_fmac_f32 v87, v138, v17
    v_mfma_f32_16x16x32_bf16 v[64:67], a[144:147], v[108:111], v[64:67]
    ds_read_b128 v[132:135], v148 offset:23552
    v_fma_f32 v80, v80, v139, v18
    v_mfma_f32_16x16x32_bf16 v[68:71], a[148:151], v[108:111], v[68:71]
    s_waitcnt lgkmcnt(4)
    v_fma_f32 v81, v81, v139, v19
    v_fma_f32 v82, v82, v139, v20
    v_mfma_f32_16x16x32_bf16 v[64:67], a[152:155], v[112:115], v[64:67]
    ds_read_b128 v[104:107], v148 offset:24576
    v_fma_f32 v83, v83, v139, v21
    v_mfma_f32_16x16x32_bf16 v[68:71], a[156:159], v[112:115], v[68:71]
    v_fma_f32 v84, v84, v139, v22
    v_fma_f32 v85, v85, v139, v23
    v_mfma_f32_16x16x32_bf16 v[64:67], a[160:163], v[116:119], v[64:67]
    ds_read_b128 v[108:111], v148 offset:25600
    v_fma_f32 v86, v86, v139, v24
    v_mfma_f32_16x16x32_bf16 v[68:71], a[164:167], v[116:119], v[68:71]
    s_waitcnt lgkmcnt(4)
    v_fma_f32 v87, v87, v139, v25
    v_max_f32 v80, 0, v80
    v_mfma_f32_16x16x32_bf16 v[72:75], v[168:171], v[120:123], 0
    ds_read_b128 v[112:115], v148 offset:26624
    v_max_f32 v81, 0, v81
    v_mfma_f32_16x16x32_bf16 v[76:79], v[172:175], v[120:123], 0
    v_max_f32 v82, 0, v82
    v_max_f32 v83, 0, v83
    v_mfma_f32_16x16x32_bf16 v[72:75], v[176:179], v[124:127], v[72:75]
    ds_read_b128 v[116:119], v148 offset:27648
    v_max_f32 v84, 0, v84
    v_mfma_f32_16x16x32_bf16 v[76:79], v[180:183], v[124:127], v[76:79]
    s_waitcnt lgkmcnt(4)
    v_max_f32 v85, 0, v85
    v_max_f32 v86, 0, v86
    v_mfma_f32_16x16x32_bf16 v[72:75], v[184:187], v[128:131], v[72:75]
    ds_read_b128 v[120:123], v148 offset:28672
    v_max_f32 v87, 0, v87
    v_mfma_f32_16x16x32_bf16 v[76:79], v[188:191], v[128:131], v[76:79]
    v_mul_f32 v80, v80, v80
    v_mul_f32 v81, v81, v81
    v_mfma_f32_16x16x32_bf16 v[72:75], v[192:195], v[132:135], v[72:75]
    ds_read_b128 v[124:127], v148 offset:29696
    v_mul_f32 v82, v82, v82
    v_mfma_f32_16x16x32_bf16 v[76:79], v[196:199], v[132:135], v[76:79]
    s_waitcnt lgkmcnt(4)
    v_mul_f32 v83, v83, v83
    v_mul_f32 v84, v84, v84
    v_mfma_f32_16x16x32_bf16 v[72:75], v[200:203], v[104:107], v[72:75]
    ds_read_b128 v[128:131], v148 offset:30720
    v_mul_f32 v85, v85, v85
    v_mfma_f32_16x16x32_bf16 v[76:79], v[204:207], v[104:107], v[76:79]
    v_mul_f32 v86, v86, v86
    v_mul_f32 v87, v87, v87
    v_mfma_f32_16x16x32_bf16 v[72:75], v[208:211], v[108:111], v[72:75]
    ds_read_b128 v[132:135], v148 offset:31744
    v_mfma_f32_16x16x32_bf16 v[76:79], v[212:215], v[108:111], v[76:79]
    ds_read_b64 v[138:139], v151 offset:896
    s_waitcnt lgkmcnt(5)
    v_mfma_f32_16x16x32_bf16 v[72:75], v[216:219], v[112:115], v[72:75]
    ds_read_b128 v[104:107], v148 offset:32768
    v_cvt_pk_bf16_f32 v144, v80, v81
    v_mfma_f32_16x16x32_bf16 v[76:79], v[220:223], v[112:115], v[76:79]
    v_cvt_pk_bf16_f32 v145, v82, v83
    v_cvt_pk_bf16_f32 v146, v84, v85
    v_mfma_f32_16x16x32_bf16 v[72:75], v[224:227], v[116:119], v[72:75]
    ds_read_b128 v[108:111], v148 offset:33792
    v_cvt_pk_bf16_f32 v147, v86, v87
    v_mfma_f32_16x16x32_bf16 v[76:79], v[228:231], v[116:119], v[76:79]
    buffer_store_dwordx4 v[144:147], v1, s[4:7], s56 offen sc1
    s_waitcnt lgkmcnt(5)
    v_mfma_f32_16x16x32_bf16 v[72:75], v[232:235], v[120:123], v[72:75]
    ds_read_b128 v[112:115], v148 offset:34816
    s_add_u32 s56, s41, 331776
    v_mfma_f32_16x16x32_bf16 v[76:79], v[236:239], v[120:123], v[76:79]
    v_fmac_f32 v64, v136, v10
    v_fmac_f32 v65, v136, v11
    v_mfma_f32_16x16x32_bf16 v[72:75], v[240:243], v[124:127], v[72:75]
    ds_read_b128 v[116:119], v148 offset:35840
    v_fmac_f32 v66, v136, v12
    v_mfma_f32_16x16x32_bf16 v[76:79], v[244:247], v[124:127], v[76:79]
    s_waitcnt lgkmcnt(5)
    v_fmac_f32 v67, v136, v13
    v_fmac_f32 v68, v136, v14
    v_mfma_f32_16x16x32_bf16 v[72:75], v[248:251], v[128:131], v[72:75]
    ds_read_b128 v[120:123], v148 offset:36864
    v_fmac_f32 v69, v136, v15
    v_mfma_f32_16x16x32_bf16 v[76:79], v[252:255], v[128:131], v[76:79]
    v_fmac_f32 v70, v136, v16
    v_fmac_f32 v71, v136, v17
    v_mfma_f32_16x16x32_bf16 v[72:75], a[168:171], v[132:135], v[72:75]
    ds_read_b128 v[124:127], v148 offset:37888
    v_fma_f32 v64, v64, v137, v18
    v_mfma_f32_16x16x32_bf16 v[76:79], a[100:103], v[132:135], v[76:79]
    s_waitcnt lgkmcnt(4)
    v_fma_f32 v65, v65, v137, v19
    v_fma_f32 v66, v66, v137, v20
    v_mfma_f32_16x16x32_bf16 v[72:75], a[104:107], v[104:107], v[72:75]
    ds_read_b128 v[128:131], v148 offset:38912
    v_fma_f32 v67, v67, v137, v21
    v_mfma_f32_16x16x32_bf16 v[76:79], a[108:111], v[104:107], v[76:79]
    v_fma_f32 v68, v68, v137, v22
    v_fma_f32 v69, v69, v137, v23
    v_mfma_f32_16x16x32_bf16 v[72:75], a[112:115], v[108:111], v[72:75]
    ds_read_b128 v[132:135], v148 offset:39936
    v_fma_f32 v70, v70, v137, v24
    v_mfma_f32_16x16x32_bf16 v[76:79], a[116:119], v[108:111], v[76:79]
    s_waitcnt lgkmcnt(4)
    v_fma_f32 v71, v71, v137, v25
    v_max_f32 v64, 0, v64
    v_mfma_f32_16x16x32_bf16 v[72:75], a[120:123], v[112:115], v[72:75]
    v_max_f32 v65, 0, v65
    v_max_f32 v66, 0, v66
    v_mfma_f32_16x16x32_bf16 v[76:79], a[124:127], v[112:115], v[76:79]
    v_max_f32 v67, 0, v67
    v_max_f32 v68, 0, v68
    v_mfma_f32_16x16x32_bf16 v[72:75], a[128:131], v[116:119], v[72:75]
    v_max_f32 v69, 0, v69
    v_max_f32 v70, 0, v70
    v_mfma_f32_16x16x32_bf16 v[76:79], a[132:135], v[116:119], v[76:79]
    s_waitcnt lgkmcnt(2)
    v_max_f32 v71, 0, v71
    v_mul_f32 v64, v64, v64
    v_mfma_f32_16x16x32_bf16 v[72:75], a[136:139], v[120:123], v[72:75]
    v_mul_f32 v65, v65, v65
    v_mul_f32 v66, v66, v66
    v_mfma_f32_16x16x32_bf16 v[76:79], a[140:143], v[120:123], v[76:79]
    v_mul_f32 v67, v67, v67
    v_mul_f32 v68, v68, v68
    v_mfma_f32_16x16x32_bf16 v[72:75], a[144:147], v[124:127], v[72:75]
    v_mul_f32 v69, v69, v69
    v_mul_f32 v70, v70, v70
    v_mfma_f32_16x16x32_bf16 v[76:79], a[148:151], v[124:127], v[76:79]
    s_waitcnt lgkmcnt(0)
    v_mul_f32 v71, v71, v71
    v_cvt_pk_bf16_f32 v140, v64, v65
    v_mfma_f32_16x16x32_bf16 v[72:75], a[152:155], v[128:131], v[72:75]
    v_cvt_pk_bf16_f32 v141, v66, v67
    v_cvt_pk_bf16_f32 v142, v68, v69
    v_mfma_f32_16x16x32_bf16 v[76:79], a[156:159], v[128:131], v[76:79]
    v_cvt_pk_bf16_f32 v143, v70, v71
    v_mfma_f32_16x16x32_bf16 v[72:75], a[160:163], v[132:135], v[72:75]
    buffer_store_dwordx4 v[140:143], v1, s[4:7], s56 offen sc1
    v_mfma_f32_16x16x32_bf16 v[76:79], a[164:167], v[132:135], v[76:79]
    s_add_u32 s56, s41, 387072
    s_nop 4
    v_pk_fma_f32 v[72:73], v[138:139], v[10:11], v[72:73] op_sel_hi:[0,1,1]
    v_pk_fma_f32 v[74:75], v[138:139], v[12:13], v[74:75] op_sel_hi:[0,1,1]
    v_pk_fma_f32 v[76:77], v[138:139], v[14:15], v[76:77] op_sel_hi:[0,1,1]
    v_pk_fma_f32 v[78:79], v[138:139], v[16:17], v[78:79] op_sel_hi:[0,1,1]
    v_pk_fma_f32 v[72:73], v[138:139], v[72:73], v[18:19] op_sel:[1,0,0]
    v_pk_fma_f32 v[74:75], v[138:139], v[74:75], v[20:21] op_sel:[1,0,0]
    v_pk_fma_f32 v[76:77], v[138:139], v[76:77], v[22:23] op_sel:[1,0,0]
    v_pk_fma_f32 v[78:79], v[138:139], v[78:79], v[24:25] op_sel:[1,0,0]
    v_max_f32 v72, 0, v72
    v_max_f32 v73, 0, v73
    v_max_f32 v74, 0, v74
    v_max_f32 v75, 0, v75
    v_max_f32 v76, 0, v76
    v_max_f32 v77, 0, v77
    v_max_f32 v78, 0, v78
    v_max_f32 v79, 0, v79
    v_pk_mul_f32 v[72:73], v[72:73], v[72:73]
    v_pk_mul_f32 v[74:75], v[74:75], v[74:75]
    v_pk_mul_f32 v[76:77], v[76:77], v[76:77]
    v_pk_mul_f32 v[78:79], v[78:79], v[78:79]
    v_cvt_pk_bf16_f32 v144, v72, v73
    v_cvt_pk_bf16_f32 v145, v74, v75
    v_cvt_pk_bf16_f32 v146, v76, v77
    v_cvt_pk_bf16_f32 v147, v78, v79
    buffer_store_dwordx4 v[144:147], v1, s[4:7], s56 offen sc1
    s_add_u32 s95, s95, 1
    v_mov_b32 v162, s95
    s_mov_b64 exec, 1
    s_cmp_eq_u32 s23, 0
    s_cbranch_scc1 slow_41
    s_waitcnt vmcnt(0)
    buffer_store_dword v162, v63, s[4:7], s60 offen
    s_branch join_42
    s_nop 0
slow_41:
    s_waitcnt vmcnt(0)
    buffer_store_dword v162, v63, s[4:7], s60 offen sc1
    s_nop 1
join_42:
    s_mov_b64 exec, -1
    s_add_u32 s58, s89, 45056
    buffer_load_dwordx4 a[168:171], v1, s[4:7], s58 offen offset:3072
    s_add_u32 s58, s89, 49152
    buffer_load_dwordx4 v[168:171], v1, s[4:7], s58 offen offset:0
    buffer_load_dwordx4 v[172:175], v1, s[4:7], s58 offen offset:1024
    buffer_load_dwordx4 v[176:179], v1, s[4:7], s58 offen offset:2048
    buffer_load_dwordx4 v[180:183], v1, s[4:7], s58 offen offset:3072
    s_add_u32 s58, s89, 53248
    buffer_load_dwordx4 v[184:187], v1, s[4:7], s58 offen offset:0
    buffer_load_dwordx4 v[188:191], v1, s[4:7], s58 offen offset:1024
    buffer_load_dwordx4 v[192:195], v1, s[4:7], s58 offen offset:2048
    buffer_load_dwordx4 v[196:199], v1, s[4:7], s58 offen offset:3072
    s_add_u32 s58, s89, 57344
    buffer_load_dwordx4 v[200:203], v1, s[4:7], s58 offen offset:0
    buffer_load_dwordx4 v[204:207], v1, s[4:7], s58 offen offset:1024
    buffer_load_dwordx4 v[208:211], v1, s[4:7], s58 offen offset:2048
    buffer_load_dwordx4 v[212:215], v1, s[4:7], s58 offen offset:3072
    s_add_u32 s58, s89, 61440
    buffer_load_dwordx4 v[216:219], v1, s[4:7], s58 offen offset:0
    buffer_load_dwordx4 v[220:223], v1, s[4:7], s58 offen offset:1024
    buffer_load_dwordx4 v[224:227], v1, s[4:7], s58 offen offset:2048
    buffer_load_dwordx4 v[228:231], v1, s[4:7], s58 offen offset:3072
    s_add_u32 s58, s89, 65536
    buffer_load_dwordx4 v[232:235], v1, s[4:7], s58 offen offset:0
    buffer_load_dwordx4 v[236:239], v1, s[4:7], s90 offen offset:0
    buffer_load_dwordx4 v[240:243], v1, s[4:7], s90 offen offset:1024
    buffer_load_dwordx4 v[244:247], v1, s[4:7], s90 offen offset:2048
    buffer_load_dwordx4 v[248:251], v1, s[4:7], s90 offen offset:3072
    s_add_u32 s58, s90, 4096
    buffer_load_dwordx4 v[252:255], v1, s[4:7], s58 offen
    s_branch p3_join_40
    s_nop 0
p3_skip_39:
    s_add_u32 s95, s95, 1
    v_mov_b32 v162, s95
    s_mov_b64 exec, 1
    s_cmp_eq_u32 s23, 0
    s_cbranch_scc1 slow_43
    buffer_store_dword v162, v63, s[4:7], s60 offen
    s_branch join_44
    s_nop 0
slow_43:
    buffer_store_dword v162, v63, s[4:7], s60 offen sc1
    s_nop 1
join_44:
    s_mov_b64 exec, -1
    s_add_u32 s58, s89, 16384
    buffer_load_dwordx4 a[248:251], v1, s[4:7], s58 offen offset:3072
    s_add_u32 s58, s89, 20480
    buffer_load_dwordx4 a[252:255], v1, s[4:7], s58 offen offset:0
    buffer_load_dwordx4 v[164:167], v1, s[4:7], s58 offen offset:1024
    buffer_load_dwordx4 a[0:3], v1, s[4:7], s58 offen offset:2048
    buffer_load_dwordx4 a[4:7], v1, s[4:7], s58 offen offset:3072
    s_add_u32 s58, s89, 24576
    buffer_load_dwordx4 a[8:11], v1, s[4:7], s58 offen offset:0
    buffer_load_dwordx4 a[12:15], v1, s[4:7], s58 offen offset:1024
    buffer_load_dwordx4 a[16:19], v1, s[4:7], s58 offen offset:2048
    buffer_load_dwordx4 a[20:23], v1, s[4:7], s58 offen offset:3072
    s_add_u32 s58, s89, 28672
    buffer_load_dwordx4 a[24:27], v1, s[4:7], s58 offen offset:0
    buffer_load_dwordx4 a[28:31], v1, s[4:7], s58 offen offset:1024
    buffer_load_dwordx4 a[32:35], v1, s[4:7], s58 offen offset:2048
    buffer_load_dwordx4 a[36:39], v1, s[4:7], s58 offen offset:3072
    s_add_u32 s58, s89, 32768
    buffer_load_dwordx4 a[40:43], v1, s[4:7], s58 offen offset:0
    buffer_load_dwordx4 a[44:47], v1, s[4:7], s58 offen offset:1024
    buffer_load_dwordx4 a[48:51], v1, s[4:7], s58 offen offset:2048
    buffer_load_dwordx4 a[52:55], v1, s[4:7], s58 offen offset:3072
    s_add_u32 s58, s89, 36864
    buffer_load_dwordx4 a[56:59], v1, s[4:7], s58 offen offset:0
    buffer_load_dwordx4 a[60:63], v1, s[4:7], s58 offen offset:1024
    buffer_load_dwordx4 a[64:67], v1, s[4:7], s58 offen offset:2048
    buffer_load_dwordx4 a[68:71], v1, s[4:7], s58 offen offset:3072
    s_add_u32 s58, s89, 40960
    buffer_load_dwordx4 a[72:75], v1, s[4:7], s58 offen offset:0
    buffer_load_dwordx4 a[76:79], v1, s[4:7], s58 offen offset:1024
    buffer_load_dwordx4 a[80:83], v1, s[4:7], s58 offen offset:2048
    buffer_load_dwordx4 a[84:87], v1, s[4:7], s58 offen offset:3072
    s_add_u32 s58, s89, 45056
    buffer_load_dwordx4 a[88:91], v1, s[4:7], s58 offen offset:0
    buffer_load_dwordx4 a[92:95], v1, s[4:7], s58 offen offset:1024
    buffer_load_dwordx4 a[96:99], v1, s[4:7], s58 offen offset:2048
    buffer_load_dwordx4 a[168:171], v1, s[4:7], s58 offen offset:3072
    s_add_u32 s58, s89, 49152
    buffer_load_dwordx4 v[168:171], v1, s[4:7], s58 offen offset:0
    buffer_load_dwordx4 v[172:175], v1, s[4:7], s58 offen offset:1024
    buffer_load_dwordx4 v[176:179], v1, s[4:7], s58 offen offset:2048
    buffer_load_dwordx4 v[180:183], v1, s[4:7], s58 offen offset:3072
    s_add_u32 s58, s89, 53248
    buffer_load_dwordx4 v[184:187], v1, s[4:7], s58 offen offset:0
    buffer_load_dwordx4 v[188:191], v1, s[4:7], s58 offen offset:1024
    buffer_load_dwordx4 v[192:195], v1, s[4:7], s58 offen offset:2048
    buffer_load_dwordx4 v[196:199], v1, s[4:7], s58 offen offset:3072
    s_add_u32 s58, s89, 57344
    buffer_load_dwordx4 v[200:203], v1, s[4:7], s58 offen offset:0
    buffer_load_dwordx4 v[204:207], v1, s[4:7], s58 offen offset:1024
    buffer_load_dwordx4 v[208:211], v1, s[4:7], s58 offen offset:2048
    buffer_load_dwordx4 v[212:215], v1, s[4:7], s58 offen offset:3072
    s_add_u32 s58, s89, 61440
    buffer_load_dwordx4 v[216:219], v1, s[4:7], s58 offen offset:0
    buffer_load_dwordx4 v[220:223], v1, s[4:7], s58 offen offset:1024
    buffer_load_dwordx4 v[224:227], v1, s[4:7], s58 offen offset:2048
    buffer_load_dwordx4 v[228:231], v1, s[4:7], s58 offen offset:3072
    s_add_u32 s58, s89, 65536
    buffer_load_dwordx4 v[232:235], v1, s[4:7], s58 offen offset:0
    buffer_load_dwordx4 v[236:239], v1, s[4:7], s90 offen offset:0
    buffer_load_dwordx4 v[240:243], v1, s[4:7], s90 offen offset:1024
    buffer_load_dwordx4 v[244:247], v1, s[4:7], s90 offen offset:2048
    buffer_load_dwordx4 v[248:251], v1, s[4:7], s90 offen offset:3072
    s_add_u32 s58, s90, 4096
    buffer_load_dwordx4 v[252:255], v1, s[4:7], s58 offen
    s_nop 1
p3_join_40:
    s_lshl_b32 s40, s20, 3
    s_lshr_b32 s3, s21, 3
    s_lshl_b32 s3, s3, 2
    s_add_u32 s40, s40, s3
    s_mul_i32 s40, s40, 54
    s_add_u32 s40, s40, s59
    s_lshl_b32 s40, s40, 10
    s_mul_i32 s3, s24, 7077888
    s_add_u32 s40, s40, s3
    s_add_u32 s40, s40, 23592960
    s_add_u32 s3, s22, 1
    s_and_b32 s3, s3, 3
    s_mul_i32 s41, s3, 55296
    s_add_u32 s41, s41, s40
    s_mul_i32 s52, s3, 15360
    s_add_u32 s48, s41, 13312
    s_cmp_ge_u32 s22, 2
    s_cselect_b32 s48, 1073741824, s48
    s_add_u32 s3, s22, 2
    s_and_b32 s3, s3, 3
    s_mul_i32 s42, s3, 55296
    s_add_u32 s42, s42, s40
    s_mul_i32 s53, s3, 15360
    s_add_u32 s49, s42, 13312
    s_cmp_ge_u32 s22, 2
    s_cselect_b32 s49, 1073741824, s49
    s_add_u32 s3, s22, 3
    s_and_b32 s3, s3, 3
    s_mul_i32 s43, s3, 55296
    s_add_u32 s43, s43, s40
    s_mul_i32 s54, s3, 15360
    s_add_u32 s50, s43, 13312
    s_cmp_ge_u32 s22, 2
    s_cselect_b32 s50, 1073741824, s50
    s_add_u32 s3, s22, 4
    s_and_b32 s3, s3, 3
    s_mul_i32 s44, s3, 55296
    s_add_u32 s44, s44, s40
    s_add_u32 s51, s44, 13312
    s_cmp_ge_u32 s22, 2
    s_cselect_b32 s51, 1073741824, s51
    s_mul_i32 s3, s22, 15360
    v_add_u32 v161, s3, v1
    s_add_u32 s36, s29, s91
    s_add_u32 s36, s36, 13107200
    s_lshl_b32 s3, s24, 18
    s_add_u32 s37, s31, s3
    s_add_u32 s37, s37, 38010880
    s_lshl_b32 s38, s20, 7
    s_lshl_b32 s3, s25, 2
    s_add_u32 s38, s38, s3
    s_add_u32 s38, s38, 38277120
    s_cmp_eq_u32 s26, 7
    s_cselect_b32 s38, s38, 1073741824
    s_mov_b32 s3, 0
    s_nop 0
poll_45:
    buffer_load_dword v162, v62, s[4:7], s61 offen offset:0 sc1
    s_add_u32 s3, s3, 1
    s_waitcnt vmcnt(0)
    v_cmp_gt_u32 vcc, s95, v162
    s_cmp_gt_u32 s3, 200000
    s_cbranch_scc1 polld_46
    s_cbranch_vccnz poll_45
    s_nop 1
polld_46:
    s_add_u32 s57, s41, 0
    buffer_load_dwordx4 v[104:107], v1, s[4:7], s57 offen offset:0 sc1
    buffer_load_dwordx4 v[108:111], v1, s[4:7], s57 offen offset:1024 sc1
    buffer_load_dwordx4 v[112:115], v1, s[4:7], s57 offen offset:2048 sc1
    buffer_load_dwordx4 v[116:119], v1, s[4:7], s57 offen offset:3072 sc1
    s_add_u32 s57, s41, 4096
    buffer_load_dwordx4 v[120:123], v1, s[4:7], s57 offen offset:0 sc1
    buffer_load_dwordx4 v[124:127], v1, s[4:7], s57 offen offset:1024 sc1
    s_waitcnt vmcnt(5)
    v_mfma_f32_16x16x32_bf16 v[64:67], a[172:175], v[104:107], 0
    buffer_load_dwordx4 v[128:131], v1, s[4:7], s57 offen offset:2048 sc1
    s_add_u32 s58, s62, 0
    v_mfma_f32_16x16x32_bf16 v[68:71], a[176:179], v[104:107], 0
    v_mfma_f32_16x16x32_bf16 v[72:75], a[180:183], v[104:107], 0
    buffer_load_dwordx4 v[132:135], v1, s[4:7], s57 offen offset:3072 sc1
    v_mfma_f32_16x16x32_bf16 v[76:79], a[184:187], v[104:107], 0
    v_mfma_f32_16x16x32_bf16 v[80:83], a[188:191], v[104:107], 0
    s_add_u32 s57, s41, 8192
    buffer_load_dwordx4 v[136:139], v1, s[4:7], s57 offen offset:0 sc1
    s_waitcnt vmcnt(7)
    v_mfma_f32_16x16x32_bf16 v[64:67], a[192:195], v[108:111], v[64:67]
    buffer_load_dwordx4 v[140:143], v1, s[4:7], s57 offen offset:1024 sc1
    v_mfma_f32_16x16x32_bf16 v[68:71], a[196:199], v[108:111], v[68:71]
    v_mfma_f32_16x16x32_bf16 v[72:75], a[200:203], v[108:111], v[72:75]
    buffer_load_dwordx4 v[144:147], v1, s[4:7], s57 offen offset:2048 sc1
    v_mfma_f32_16x16x32_bf16 v[76:79], a[204:207], v[108:111], v[76:79]
    v_mfma_f32_16x16x32_bf16 v[80:83], a[208:211], v[108:111], v[80:83]
    buffer_load_dwordx4 v[148:151], v1, s[4:7], s57 offen offset:3072 sc1
    s_waitcnt vmcnt(9)
    v_mfma_f32_16x16x32_bf16 v[64:67], a[212:215], v[112:115], v[64:67]
    s_add_u32 s57, s41, 12288
    buffer_load_dwordx4 v[152:155], v1, s[4:7], s57 offen offset:0 sc1
    v_mfma_f32_16x16x32_bf16 v[68:71], a[216:219], v[112:115], v[68:71]
    v_mfma_f32_16x16x32_bf16 v[72:75], a[220:223], v[112:115], v[72:75]
    buffer_load_dwordx4 v[156:159], v1, s[4:7], s48 offen sc1
    v_mfma_f32_16x16x32_bf16 v[76:79], a[224:227], v[112:115], v[76:79]
    v_mfma_f32_16x16x32_bf16 v[80:83], a[228:231], v[112:115], v[80:83]
    s_add_u32 s57, s42, 0
    buffer_load_dwordx4 v[104:107], v1, s[4:7], s57 offen offset:0 sc1
    s_waitcnt vmcnt(11)
    v_mfma_f32_16x16x32_bf16 v[64:67], a[232:235], v[116:119], v[64:67]
    buffer_load_dwordx4 v[108:111], v1, s[4:7], s57 offen offset:1024 sc1
    v_mfma_f32_16x16x32_bf16 v[68:71], a[236:239], v[116:119], v[68:71]
    v_mfma_f32_16x16x32_bf16 v[72:75], a[240:243], v[116:119], v[72:75]
    buffer_load_dwordx4 v[112:115], v1, s[4:7], s57 offen offset:2048 sc1
    v_mfma_f32_16x16x32_bf16 v[76:79], a[244:247], v[116:119], v[76:79]
    v_mfma_f32_16x16x32_bf16 v[80:83], a[248:251], v[116:119], v[80:83]
    buffer_load_dwordx4 v[116:119], v1, s[4:7], s57 offen offset:3072 sc1
    s_waitcnt vmcnt(13)
    v_mfma_f32_16x16x32_bf16 v[64:67], a[252:255], v[120:123], v[64:67]
    v_mfma_f32_16x16x32_bf16 v[68:71], v[164:167], v[120:123], v[68:71]
    v_mfma_f32_16x16x32_bf16 v[72:75], a[0:3], v[120:123], v[72:75]
    v_mfma_f32_16x16x32_bf16 v[76:79], a[4:7], v[120:123], v[76:79]
    buffer_load_dwordx4 a[100:103], v1, s[16:19], s58 offen offset:0
    v_mfma_f32_16x16x32_bf16 v[80:83], a[8:11], v[120:123], v[80:83]
    s_add_u32 s57, s42, 4096
    buffer_load_dwordx4 v[120:123], v1, s[4:7], s57 offen offset:0 sc1
    s_waitcnt vmcnt(14)
    v_mfma_f32_16x16x32_bf16 v[64:67], a[12:15], v[124:127], v[64:67]
    v_mfma_f32_16x16x32_bf16 v[68:71], a[16:19], v[124:127], v[68:71]
    v_mfma_f32_16x16x32_bf16 v[72:75], a[20:23], v[124:127], v[72:75]
    v_mfma_f32_16x16x32_bf16 v[76:79], a[24:27], v[124:127], v[76:79]
    buffer_load_dwordx4 a[104:107], v1, s[16:19], s58 offen offset:1024
    v_mfma_f32_16x16x32_bf16 v[80:83], a[28:31], v[124:127], v[80:83]
    buffer_load_dwordx4 v[124:127], v1, s[4:7], s57 offen offset:1024 sc1
    s_waitcnt vmcnt(15)
    v_mfma_f32_16x16x32_bf16 v[64:67], a[32:35], v[128:131], v[64:67]
    v_mfma_f32_16x16x32_bf16 v[68:71], a[36:39], v[128:131], v[68:71]
    v_mfma_f32_16x16x32_bf16 v[72:75], a[40:43], v[128:131], v[72:75]
    v_mfma_f32_16x16x32_bf16 v[76:79], a[44:47], v[128:131], v[76:79]
    buffer_load_dwordx4 a[108:111], v1, s[16:19], s58 offen offset:2048
    v_mfma_f32_16x16x32_bf16 v[80:83], a[48:51], v[128:131], v[80:83]
    buffer_load_dwordx4 v[128:131], v1, s[4:7], s57 offen offset:2048 sc1
    s_waitcnt vmcnt(16)
    v_mfma_f32_16x16x32_bf16 v[64:67], a[52:55], v[132:135], v[64:67]
    v_mfma_f32_16x16x32_bf16 v[68:71], a[56:59], v[132:135], v[68:71]
    v_mfma_f32_16x16x32_bf16 v[72:75], a[60:63], v[132:135], v[72:75]
    v_mfma_f32_16x16x32_bf16 v[76:79], a[64:67], v[132:135], v[76:79]
    buffer_load_dwordx4 a[112:115], v1, s[16:19], s58 offen offset:3072
    v_mfma_f32_16x16x32_bf16 v[80:83], a[68:71], v[132:135], v[80:83]
    buffer_load_dwordx4 v[132:135], v1, s[4:7], s57 offen offset:3072 sc1
    s_add_u32 s58, s62, 4096
    s_waitcnt vmcnt(17)
    v_mfma_f32_16x16x32_bf16 v[64:67], a[72:75], v[136:139], v[64:67]
    v_mfma_f32_16x16x32_bf16 v[68:71], a[76:79], v[136:139], v[68:71]
    v_mfma_f32_16x16x32_bf16 v[72:75], a[80:83], v[136:139], v[72:75]
    v_mfma_f32_16x16x32_bf16 v[76:79], a[84:87], v[136:139], v[76:79]
    buffer_load_dwordx4 a[116:119], v1, s[16:19], s58 offen offset:0
    v_mfma_f32_16x16x32_bf16 v[80:83], a[88:91], v[136:139], v[80:83]
    s_add_u32 s57, s42, 8192
    buffer_load_dwordx4 v[136:139], v1, s[4:7], s57 offen offset:0 sc1
    s_waitcnt vmcnt(18)
    v_mfma_f32_16x16x32_bf16 v[64:67], a[92:95], v[140:143], v[64:67]
    v_mfma_f32_16x16x32_bf16 v[68:71], a[96:99], v[140:143], v[68:71]
    v_mfma_f32_16x16x32_bf16 v[72:75], a[168:171], v[140:143], v[72:75]
    v_mfma_f32_16x16x32_bf16 v[76:79], v[168:171], v[140:143], v[76:79]
    buffer_load_dwordx4 a[120:123], v1, s[16:19], s58 offen offset:1024
    v_mfma_f32_16x16x32_bf16 v[80:83], v[172:175], v[140:143], v[80:83]
    buffer_load_dwordx4 v[140:143], v1, s[4:7], s57 offen offset:1024 sc1
    s_waitcnt vmcnt(19)
    v_mfma_f32_16x16x32_bf16 v[64:67], v[176:179], v[144:147], v[64:67]
    v_mfma_f32_16x16x32_bf16 v[68:71], v[180:183], v[144:147], v[68:71]
    v_mfma_f32_16x16x32_bf16 v[72:75], v[184:187], v[144:147], v[72:75]
    v_mfma_f32_16x16x32_bf16 v[76:79], v[188:191], v[144:147], v[76:79]
    buffer_load_dwordx4 a[124:127], v1, s[16:19], s58 offen offset:2048
    v_mfma_f32_16x16x32_bf16 v[80:83], v[192:195], v[144:147], v[80:83]
    buffer_load_dwordx4 v[144:147], v1, s[4:7], s57 offen offset:2048 sc1
    s_waitcnt vmcnt(20)
    v_mfma_f32_16x16x32_bf16 v[64:67], v[196:199], v[148:151], v[64:67]
    v_mfma_f32_16x16x32_bf16 v[68:71], v[200:203], v[148:151], v[68:71]
    v_mfma_f32_16x16x32_bf16 v[72:75], v[204:207], v[148:151], v[72:75]
    v_mfma_f32_16x16x32_bf16 v[76:79], v[208:211], v[148:151], v[76:79]
    buffer_load_dwordx4 a[128:131], v1, s[16:19], s58 offen offset:3072
    v_mfma_f32_16x16x32_bf16 v[80:83], v[212:215], v[148:151], v[80:83]
    buffer_load_dwordx4 v[148:151], v1, s[4:7], s57 offen offset:3072 sc1
    s_add_u32 s58, s62, 8192
    s_waitcnt vmcnt(21)
    v_mfma_f32_16x16x32_bf16 v[64:67], v[216:219], v[152:155], v[64:67]
    v_mfma_f32_16x16x32_bf16 v[68:71], v[220:223], v[152:155], v[68:71]
    v_mfma_f32_16x16x32_bf16 v[72:75], v[224:227], v[152:155], v[72:75]
    v_mfma_f32_16x16x32_bf16 v[76:79], v[228:231], v[152:155], v[76:79]
    buffer_load_dwordx4 a[132:135], v1, s[16:19], s58 offen offset:0
    v_mfma_f32_16x16x32_bf16 v[80:83], v[232:235], v[152:155], v[80:83]
    s_add_u32 s57, s42, 12288
    buffer_load_dwordx4 v[152:155], v1, s[4:7], s57 offen offset:0 sc1
    s_waitcnt vmcnt(22)
    v_mfma_f32_16x16x32_bf16 v[64:67], v[236:239], v[156:159], v[64:67]
    v_mfma_f32_16x16x32_bf16 v[68:71], v[240:243], v[156:159], v[68:71]
    v_mfma_f32_16x16x32_bf16 v[72:75], v[244:247], v[156:159], v[72:75]
    v_mfma_f32_16x16x32_bf16 v[76:79], v[248:251], v[156:159], v[76:79]
    buffer_load_dwordx4 a[136:139], v1, s[16:19], s58 offen offset:1024
    v_mfma_f32_16x16x32_bf16 v[80:83], v[252:255], v[156:159], v[80:83]
    buffer_load_dwordx4 v[156:159], v1, s[4:7], s49 offen sc1
    s_waitcnt vmcnt(23)
    v_mfma_f32_16x16x32_bf16 v[84:87], a[172:175], v[104:107], 0
    v_mfma_f32_16x16x32_bf16 v[88:91], a[176:179], v[104:107], 0
    v_mfma_f32_16x16x32_bf16 v[92:95], a[180:183], v[104:107], 0
    v_mfma_f32_16x16x32_bf16 v[96:99], a[184:187], v[104:107], 0
    buffer_load_dwordx4 a[140:143], v1, s[16:19], s58 offen offset:2048
    v_add_u32 v160, s52, v1
    v_mfma_f32_16x16x32_bf16 v[100:103], a[188:191], v[104:107], 0
    s_add_u32 s57, s43, 0
    buffer_load_dwordx4 v[104:107], v1, s[4:7], s57 offen offset:0 sc1
    s_waitcnt vmcnt(24)
    v_mfma_f32_16x16x32_bf16 v[84:87], a[192:195], v[108:111], v[84:87]
    ds_write_b128 v160, v[64:67] offset:0
    v_mfma_f32_16x16x32_bf16 v[88:91], a[196:199], v[108:111], v[88:91]
    ds_write_b128 v160, v[68:71] offset:1024
    v_mfma_f32_16x16x32_bf16 v[92:95], a[200:203], v[108:111], v[92:95]
    ds_write_b128 v160, v[72:75] offset:2048
    v_mfma_f32_16x16x32_bf16 v[96:99], a[204:207], v[108:111], v[96:99]
    buffer_load_dwordx4 a[144:147], v1, s[16:19], s58 offen offset:3072
    v_mfma_f32_16x16x32_bf16 v[100:103], a[208:211], v[108:111], v[100:103]
    buffer_load_dwordx4 v[108:111], v1, s[4:7], s57 offen offset:1024 sc1
    s_add_u32 s58, s62, 12288
    s_waitcnt vmcnt(25)
    v_mfma_f32_16x16x32_bf16 v[84:87], a[212:215], v[112:115], v[84:87]
    ds_write_b128 v160, v[76:79] offset:3072
    v_mfma_f32_16x16x32_bf16 v[88:91], a[216:219], v[112:115], v[88:91]
    ds_write_b128 v160, v[80:83] offset:4096
    v_mfma_f32_16x16x32_bf16 v[92:95], a[220:223], v[112:115], v[92:95]
    v_mfma_f32_16x16x32_bf16 v[96:99], a[224:227], v[112:115], v[96:99]
    buffer_load_dwordx4 a[148:151], v1, s[16:19], s58 offen offset:0
    v_mfma_f32_16x16x32_bf16 v[100:103], a[228:231], v[112:115], v[100:103]
    buffer_load_dwordx4 v[112:115], v1, s[4:7], s57 offen offset:2048 sc1
    s_waitcnt vmcnt(26)
    v_mfma_f32_16x16x32_bf16 v[84:87], a[232:235], v[116:119], v[84:87]
    v_mfma_f32_16x16x32_bf16 v[88:91], a[236:239], v[116:119], v[88:91]
    v_mfma_f32_16x16x32_bf16 v[92:95], a[240:243], v[116:119], v[92:95]
    v_mfma_f32_16x16x32_bf16 v[96:99], a[244:247], v[116:119], v[96:99]
    buffer_load_dwordx4 a[152:155], v1, s[16:19], s58 offen offset:1024
    v_mfma_f32_16x16x32_bf16 v[100:103], a[248:251], v[116:119], v[100:103]
    buffer_load_dwordx4 v[116:119], v1, s[4:7], s57 offen offset:3072 sc1
    s_waitcnt vmcnt(26)
    v_mfma_f32_16x16x32_bf16 v[84:87], a[252:255], v[120:123], v[84:87]
    v_mfma_f32_16x16x32_bf16 v[88:91], v[164:167], v[120:123], v[88:91]
    v_mfma_f32_16x16x32_bf16 v[92:95], a[0:3], v[120:123], v[92:95]
    v_mfma_f32_16x16x32_bf16 v[96:99], a[4:7], v[120:123], v[96:99]
    buffer_load_dwordx4 a[156:159], v1, s[16:19], s58 offen offset:2048
    v_mfma_f32_16x16x32_bf16 v[100:103], a[8:11], v[120:123], v[100:103]
    s_add_u32 s57, s43, 4096
    buffer_load_dwordx4 v[120:123], v1, s[4:7], s57 offen offset:0 sc1
    s_waitcnt vmcnt(26)
    v_mfma_f32_16x16x32_bf16 v[84:87], a[12:15], v[124:127], v[84:87]
    v_mfma_f32_16x16x32_bf16 v[88:91], a[16:19], v[124:127], v[88:91]
    v_mfma_f32_16x16x32_bf16 v[92:95], a[20:23], v[124:127], v[92:95]
    v_mfma_f32_16x16x32_bf16 v[96:99], a[24:27], v[124:127], v[96:99]
    buffer_load_dwordx4 a[160:163], v1, s[16:19], s58 offen offset:3072
    v_mfma_f32_16x16x32_bf16 v[100:103], a[28:31], v[124:127], v[100:103]
    buffer_load_dwordx4 v[124:127], v1, s[4:7], s57 offen offset:1024 sc1
    s_add_u32 s58, s62, 16384
    s_waitcnt vmcnt(26)
    v_mfma_f32_16x16x32_bf16 v[84:87], a[32:35], v[128:131], v[84:87]
    v_mfma_f32_16x16x32_bf16 v[88:91], a[36:39], v[128:131], v[88:91]
    v_mfma_f32_16x16x32_bf16 v[92:95], a[40:43], v[128:131], v[92:95]
    v_mfma_f32_16x16x32_bf16 v[96:99], a[44:47], v[128:131], v[96:99]
    buffer_load_dwordx4 a[164:167], v1, s[16:19], s58 offen offset:0
    v_mfma_f32_16x16x32_bf16 v[100:103], a[48:51], v[128:131], v[100:103]
    buffer_load_dwordx4 v[128:131], v1, s[4:7], s57 offen offset:2048 sc1
    s_waitcnt vmcnt(26)
    v_mfma_f32_16x16x32_bf16 v[84:87], a[52:55], v[132:135], v[84:87]
    v_mfma_f32_16x16x32_bf16 v[88:91], a[56:59], v[132:135], v[88:91]
    v_mfma_f32_16x16x32_bf16 v[92:95], a[60:63], v[132:135], v[92:95]
    v_mfma_f32_16x16x32_bf16 v[96:99], a[64:67], v[132:135], v[96:99]
    v_mfma_f32_16x16x32_bf16 v[100:103], a[68:71], v[132:135], v[100:103]
    buffer_load_dwordx4 v[132:135], v1, s[4:7], s57 offen offset:3072 sc1
    s_waitcnt vmcnt(25)
    v_mfma_f32_16x16x32_bf16 v[84:87], a[72:75], v[136:139], v[84:87]
    v_mfma_f32_16x16x32_bf16 v[88:91], a[76:79], v[136:139], v[88:91]
    v_mfma_f32_16x16x32_bf16 v[92:95], a[80:83], v[136:139], v[92:95]
    v_mfma_f32_16x16x32_bf16 v[96:99], a[84:87], v[136:139], v[96:99]
    v_mfma_f32_16x16x32_bf16 v[100:103], a[88:91], v[136:139], v[100:103]
    s_add_u32 s57, s43, 8192
    buffer_load_dwordx4 v[136:139], v1, s[4:7], s57 offen offset:0 sc1
    s_waitcnt vmcnt(24)
    v_mfma_f32_16x16x32_bf16 v[84:87], a[92:95], v[140:143], v[84:87]
    v_mfma_f32_16x16x32_bf16 v[88:91], a[96:99], v[140:143], v[88:91]
    v_mfma_f32_16x16x32_bf16 v[92:95], a[168:171], v[140:143], v[92:95]
    v_mfma_f32_16x16x32_bf16 v[96:99], v[168:171], v[140:143], v[96:99]
    v_mfma_f32_16x16x32_bf16 v[100:103], v[172:175], v[140:143], v[100:103]
    buffer_load_dwordx4 v[140:143], v1, s[4:7], s57 offen offset:1024 sc1
    s_waitcnt vmcnt(23)
    v_mfma_f32_16x16x32_bf16 v[84:87], v[176:179], v[144:147], v[84:87]
    v_mfma_f32_16x16x32_bf16 v[88:91], v[180:183], v[144:147], v[88:91]
    v_mfma_f32_16x16x32_bf16 v[92:95], v[184:187], v[144:147], v[92:95]
    v_mfma_f32_16x16x32_bf16 v[96:99], v[188:191], v[144:147], v[96:99]
    v_mfma_f32_16x16x32_bf16 v[100:103], v[192:195], v[144:147], v[100:103]
    buffer_load_dwordx4 v[144:147], v1, s[4:7], s57 offen offset:2048 sc1
    s_waitcnt vmcnt(22)
    v_mfma_f32_16x16x32_bf16 v[84:87], v[196:199], v[148:151], v[84:87]
    v_mfma_f32_16x16x32_bf16 v[88:91], v[200:203], v[148:151], v[88:91]
    v_mfma_f32_16x16x32_bf16 v[92:95], v[204:207], v[148:151], v[92:95]
    v_mfma_f32_16x16x32_bf16 v[96:99], v[208:211], v[148:151], v[96:99]
    v_mfma_f32_16x16x32_bf16 v[100:103], v[212:215], v[148:151], v[100:103]
    buffer_load_dwordx4 v[148:151], v1, s[4:7], s57 offen offset:3072 sc1
    s_waitcnt vmcnt(21)
    v_mfma_f32_16x16x32_bf16 v[84:87], v[216:219], v[152:155], v[84:87]
    v_mfma_f32_16x16x32_bf16 v[88:91], v[220:223], v[152:155], v[88:91]
    v_mfma_f32_16x16x32_bf16 v[92:95], v[224:227], v[152:155], v[92:95]
    v_mfma_f32_16x16x32_bf16 v[96:99], v[228:231], v[152:155], v[96:99]
    v_mfma_f32_16x16x32_bf16 v[100:103], v[232:235], v[152:155], v[100:103]
    s_add_u32 s57, s43, 12288
    buffer_load_dwordx4 v[152:155], v1, s[4:7], s57 offen offset:0 sc1
    s_waitcnt vmcnt(20)
    v_mfma_f32_16x16x32_bf16 v[84:87], v[236:239], v[156:159], v[84:87]
    v_mfma_f32_16x16x32_bf16 v[88:91], v[240:243], v[156:159], v[88:91]
    v_mfma_f32_16x16x32_bf16 v[92:95], v[244:247], v[156:159], v[92:95]
    v_mfma_f32_16x16x32_bf16 v[96:99], v[248:251], v[156:159], v[96:99]
    v_mfma_f32_16x16x32_bf16 v[100:103], v[252:255], v[156:159], v[100:103]
    buffer_load_dwordx4 v[156:159], v1, s[4:7], s50 offen sc1
    s_waitcnt vmcnt(19)
    v_mfma_f32_16x16x32_bf16 v[64:67], a[172:175], v[104:107], 0
    v_mfma_f32_16x16x32_bf16 v[68:71], a[176:179], v[104:107], 0
    v_mfma_f32_16x16x32_bf16 v[72:75], a[180:183], v[104:107], 0
    v_mfma_f32_16x16x32_bf16 v[76:79], a[184:187], v[104:107], 0
    v_add_u32 v160, s53, v1
    v_mfma_f32_16x16x32_bf16 v[80:83], a[188:191], v[104:107], 0
    s_add_u32 s57, s44, 0
    buffer_load_dwordx4 v[104:107], v1, s[4:7], s57 offen offset:0 sc1
    s_waitcnt vmcnt(18)
    v_mfma_f32_16x16x32_bf16 v[64:67], a[192:195], v[108:111], v[64:67]
    ds_write_b128 v160, v[84:87] offset:5120
    v_mfma_f32_16x16x32_bf16 v[68:71], a[196:199], v[108:111], v[68:71]
    ds_write_b128 v160, v[88:91] offset:6144
    v_mfma_f32_16x16x32_bf16 v[72:75], a[200:203], v[108:111], v[72:75]
    ds_write_b128 v160, v[92:95] offset:7168
    v_mfma_f32_16x16x32_bf16 v[76:79], a[204:207], v[108:111], v[76:79]
    ds_write_b128 v160, v[96:99] offset:8192
    v_mfma_f32_16x16x32_bf16 v[80:83], a[208:211], v[108:111], v[80:83]
    buffer_load_dwordx4 v[108:111], v1, s[4:7], s57 offen offset:1024 sc1
    s_waitcnt vmcnt(17)
    v_mfma_f32_16x16x32_bf16 v[64:67], a[212:215], v[112:115], v[64:67]
    ds_write_b128 v160, v[100:103] offset:9216
    v_mfma_f32_16x16x32_bf16 v[68:71], a[216:219], v[112:115], v[68:71]
    v_mfma_f32_16x16x32_bf16 v[72:75], a[220:223], v[112:115], v[72:75]
    v_mfma_f32_16x16x32_bf16 v[76:79], a[224:227], v[112:115], v[76:79]
    s_waitcnt lgkmcnt(0)
    v_lshlrev_b32 v84, 16, v36
    v_and_b32 v85, 0xffff0000, v36
    v_mfma_f32_16x16x32_bf16 v[80:83], a[228:231], v[112:115], v[80:83]
    buffer_load_dwordx4 v[112:115], v1, s[4:7], s57 offen offset:2048 sc1
    v_lshlrev_b32 v86, 16, v37
    s_waitcnt vmcnt(16)
    v_mfma_f32_16x16x32_bf16 v[64:67], a[232:235], v[116:119], v[64:67]
    v_and_b32 v87, 0xffff0000, v37
    v_lshlrev_b32 v88, 16, v38
    v_mfma_f32_16x16x32_bf16 v[68:71], a[236:239], v[116:119], v[68:71]
    v_and_b32 v89, 0xffff0000, v38
    v_lshlrev_b32 v90, 16, v39
    v_mfma_f32_16x16x32_bf16 v[72:75], a[240:243], v[116:119], v[72:75]
    v_and_b32 v91, 0xffff0000, v39
    v_lshlrev_b32 v92, 16, v40
    v_mfma_f32_16x16x32_bf16 v[76:79], a[244:247], v[116:119], v[76:79]
    v_and_b32 v93, 0xffff0000, v40
    v_lshlrev_b32 v94, 16, v41
    v_mfma_f32_16x16x32_bf16 v[80:83], a[248:251], v[116:119], v[80:83]
    buffer_load_dwordx4 v[116:119], v1, s[4:7], s57 offen offset:3072 sc1
    v_and_b32 v95, 0xffff0000, v41
    s_waitcnt vmcnt(15)
    v_mfma_f32_16x16x32_bf16 v[64:67], a[252:255], v[120:123], v[64:67]
    v_lshlrev_b32 v96, 16, v42
    v_and_b32 v97, 0xffff0000, v42
    v_mfma_f32_16x16x32_bf16 v[68:71], v[164:167], v[120:123], v[68:71]
    v_lshlrev_b32 v98, 16, v43
    v_and_b32 v99, 0xffff0000, v43
    v_mfma_f32_16x16x32_bf16 v[72:75], a[0:3], v[120:123], v[72:75]
    v_lshlrev_b32 v100, 16, v44
    v_and_b32 v101, 0xffff0000, v44
    v_mfma_f32_16x16x32_bf16 v[76:79], a[4:7], v[120:123], v[76:79]
    v_lshlrev_b32 v102, 16, v45
    v_and_b32 v103, 0xffff0000, v45
    v_mfma_f32_16x16x32_bf16 v[80:83], a[8:11], v[120:123], v[80:83]
    s_add_u32 s57, s44, 4096
    buffer_load_dwordx4 v[120:123], v1, s[4:7], s57 offen offset:0 sc1
    s_waitcnt vmcnt(14)
    v_mfma_f32_16x16x32_bf16 v[64:67], a[12:15], v[124:127], v[64:67]
    v_lshlrev_b32 v162, 16, v26
    v_add_f32 v84, v84, v162
    v_mfma_f32_16x16x32_bf16 v[68:71], a[16:19], v[124:127], v[68:71]
    v_and_b32 v162, 0xffff0000, v26
    v_add_f32 v85, v85, v162
    v_mfma_f32_16x16x32_bf16 v[72:75], a[20:23], v[124:127], v[72:75]
    v_lshlrev_b32 v162, 16, v27
    v_add_f32 v86, v86, v162
    v_mfma_f32_16x16x32_bf16 v[76:79], a[24:27], v[124:127], v[76:79]
    v_and_b32 v162, 0xffff0000, v27
    v_add_f32 v87, v87, v162
    v_mfma_f32_16x16x32_bf16 v[80:83], a[28:31], v[124:127], v[80:83]
    buffer_load_dwordx4 v[124:127], v1, s[4:7], s57 offen offset:1024 sc1
    v_lshlrev_b32 v162, 16, v28
    s_waitcnt vmcnt(13)
    v_mfma_f32_16x16x32_bf16 v[64:67], a[32:35], v[128:131], v[64:67]
    v_add_f32 v88, v88, v162
    v_and_b32 v162, 0xffff0000, v28
    v_mfma_f32_16x16x32_bf16 v[68:71], a[36:39], v[128:131], v[68:71]
    v_add_f32 v89, v89, v162
    v_lshlrev_b32 v162, 16, v29
    v_mfma_f32_16x16x32_bf16 v[72:75], a[40:43], v[128:131], v[72:75]
    v_add_f32 v90, v90, v162
    v_and_b32 v162, 0xffff0000, v29
    v_mfma_f32_16x16x32_bf16 v[76:79], a[44:47], v[128:131], v[76:79]
    v_add_f32 v91, v91, v162
    v_lshlrev_b32 v162, 16, v30
    v_mfma_f32_16x16x32_bf16 v[80:83], a[48:51], v[128:131], v[80:83]
    buffer_load_dwordx4 v[128:131], v1, s[4:7], s57 offen offset:2048 sc1
    v_add_f32 v92, v92, v162
    s_waitcnt vmcnt(13)
    v_mfma_f32_16x16x32_bf16 v[64:67], a[52:55], v[132:135], v[64:67]
    v_and_b32 v162, 0xffff0000, v30
    v_add_f32 v93, v93, v162
    v_mfma_f32_16x16x32_bf16 v[68:71], a[56:59], v[132:135], v[68:71]
    v_lshlrev_b32 v162, 16, v31
    v_add_f32 v94, v94, v162
    v_mfma_f32_16x16x32_bf16 v[72:75], a[60:63], v[132:135], v[72:75]
    v_and_b32 v162, 0xffff0000, v31
    v_add_f32 v95, v95, v162
    v_mfma_f32_16x16x32_bf16 v[76:79], a[64:67], v[132:135], v[76:79]
    v_lshlrev_b32 v162, 16, v32
    v_add_f32 v96, v96, v162
    v_mfma_f32_16x16x32_bf16 v[80:83], a[68:71], v[132:135], v[80:83]
    buffer_load_dwordx4 v[132:135], v1, s[4:7], s57 offen offset:3072 sc1
    v_and_b32 v162, 0xffff0000, v32
    s_waitcnt vmcnt(13)
    v_mfma_f32_16x16x32_bf16 v[64:67], a[72:75], v[136:139], v[64:67]
    v_add_f32 v97, v97, v162
    v_lshlrev_b32 v162, 16, v33
    v_mfma_f32_16x16x32_bf16 v[68:71], a[76:79], v[136:139], v[68:71]
    v_add_f32 v98, v98, v162
    v_and_b32 v162, 0xffff0000, v33
    v_mfma_f32_16x16x32_bf16 v[72:75], a[80:83], v[136:139], v[72:75]
    v_add_f32 v99, v99, v162
    v_lshlrev_b32 v162, 16, v34
    v_mfma_f32_16x16x32_bf16 v[76:79], a[84:87], v[136:139], v[76:79]
    v_add_f32 v100, v100, v162
    v_and_b32 v162, 0xffff0000, v34
    v_mfma_f32_16x16x32_bf16 v[80:83], a[88:91], v[136:139], v[80:83]
    s_add_u32 s57, s44, 8192
    buffer_load_dwordx4 v[136:139], v1, s[4:7], s57 offen offset:0 sc1
    s_waitcnt vmcnt(13)
    v_mfma_f32_16x16x32_bf16 v[64:67], a[92:95], v[140:143], v[64:67]
    v_add_f32 v101, v101, v162
    v_lshlrev_b32 v162, 16, v35
    v_mfma_f32_16x16x32_bf16 v[68:71], a[96:99], v[140:143], v[68:71]
    v_add_f32 v102, v102, v162
    v_and_b32 v162, 0xffff0000, v35
    v_mfma_f32_16x16x32_bf16 v[72:75], a[168:171], v[140:143], v[72:75]
    v_add_f32 v103, v103, v162
    v_mfma_f32_16x16x32_bf16 v[76:79], v[168:171], v[140:143], v[76:79]
    v_mfma_f32_16x16x32_bf16 v[80:83], v[172:175], v[140:143], v[80:83]
    buffer_load_dwordx4 v[140:143], v1, s[4:7], s57 offen offset:1024 sc1
    s_waitcnt vmcnt(13)
    v_mfma_f32_16x16x32_bf16 v[64:67], v[176:179], v[144:147], v[64:67]
    v_mfma_f32_16x16x32_bf16 v[68:71], v[180:183], v[144:147], v[68:71]
    v_mfma_f32_16x16x32_bf16 v[72:75], v[184:187], v[144:147], v[72:75]
    v_mfma_f32_16x16x32_bf16 v[76:79], v[188:191], v[144:147], v[76:79]
    v_mfma_f32_16x16x32_bf16 v[80:83], v[192:195], v[144:147], v[80:83]
    buffer_load_dwordx4 v[144:147], v1, s[4:7], s57 offen offset:2048 sc1
    s_waitcnt vmcnt(13)
    v_mfma_f32_16x16x32_bf16 v[64:67], v[196:199], v[148:151], v[64:67]
    v_mfma_f32_16x16x32_bf16 v[68:71], v[200:203], v[148:151], v[68:71]
    v_mfma_f32_16x16x32_bf16 v[72:75], v[204:207], v[148:151], v[72:75]
    v_mfma_f32_16x16x32_bf16 v[76:79], v[208:211], v[148:151], v[76:79]
    v_mfma_f32_16x16x32_bf16 v[80:83], v[212:215], v[148:151], v[80:83]
    buffer_load_dwordx4 v[148:151], v1, s[4:7], s57 offen offset:3072 sc1
    s_waitcnt vmcnt(13)
    v_mfma_f32_16x16x32_bf16 v[64:67], v[216:219], v[152:155], v[64:67]
    v_mfma_f32_16x16x32_bf16 v[68:71], v[220:223], v[152:155], v[68:71]
    v_mfma_f32_16x16x32_bf16 v[72:75], v[224:227], v[152:155], v[72:75]
    v_mfma_f32_16x16x32_bf16 v[76:79], v[228:231], v[152:155], v[76:79]
    v_mfma_f32_16x16x32_bf16 v[80:83], v[232:235], v[152:155], v[80:83]
    s_add_u32 s57, s44, 12288
    buffer_load_dwordx4 v[152:155], v1, s[4:7], s57 offen offset:0 sc1
    s_waitcnt vmcnt(13)
    v_mfma_f32_16x16x32_bf16 v[64:67], v[236:239], v[156:159], v[64:67]
    v_mfma_f32_16x16x32_bf16 v[68:71], v[240:243], v[156:159], v[68:71]
    v_mfma_f32_16x16x32_bf16 v[72:75], v[244:247], v[156:159], v[72:75]
    v_mfma_f32_16x16x32_bf16 v[76:79], v[248:251], v[156:159], v[76:79]
    v_mfma_f32_16x16x32_bf16 v[80:83], v[252:255], v[156:159], v[80:83]
    buffer_load_dwordx4 v[156:159], v1, s[4:7], s51 offen sc1
    s_waitcnt vmcnt(13)
    v_mfma_f32_16x16x32_bf16 v[84:87], a[172:175], v[104:107], v[84:87]
    v_mfma_f32_16x16x32_bf16 v[88:91], a[176:179], v[104:107], v[88:91]
    v_mfma_f32_16x16x32_bf16 v[92:95], a[180:183], v[104:107], v[92:95]
    v_mfma_f32_16x16x32_bf16 v[96:99], a[184:187], v[104:107], v[96:99]
    v_add_u32 v160, s54, v1
    v_mfma_f32_16x16x32_bf16 v[100:103], a[188:191], v[104:107], v[100:103]
    ds_write_b128 v160, v[64:67] offset:10240
    s_waitcnt vmcnt(12)
    v_mfma_f32_16x16x32_bf16 v[84:87], a[192:195], v[108:111], v[84:87]
    ds_write_b128 v160, v[68:71] offset:11264
    v_mfma_f32_16x16x32_bf16 v[88:91], a[196:199], v[108:111], v[88:91]
    ds_write_b128 v160, v[72:75] offset:12288
    v_mfma_f32_16x16x32_bf16 v[92:95], a[200:203], v[108:111], v[92:95]
    ds_write_b128 v160, v[76:79] offset:13312
    v_mfma_f32_16x16x32_bf16 v[96:99], a[204:207], v[108:111], v[96:99]
    ds_write_b128 v160, v[80:83] offset:14336
    v_mfma_f32_16x16x32_bf16 v[100:103], a[208:211], v[108:111], v[100:103]
    s_waitcnt vmcnt(11)
    v_mfma_f32_16x16x32_bf16 v[84:87], a[212:215], v[112:115], v[84:87]
    v_mfma_f32_16x16x32_bf16 v[88:91], a[216:219], v[112:115], v[88:91]
    v_mfma_f32_16x16x32_bf16 v[92:95], a[220:223], v[112:115], v[92:95]
    v_mfma_f32_16x16x32_bf16 v[96:99], a[224:227], v[112:115], v[96:99]
    v_mfma_f32_16x16x32_bf16 v[100:103], a[228:231], v[112:115], v[100:103]
    s_waitcnt vmcnt(10)
    v_mfma_f32_16x16x32_bf16 v[84:87], a[232:235], v[116:119], v[84:87]
    v_mfma_f32_16x16x32_bf16 v[88:91], a[236:239], v[116:119], v[88:91]
    v_mfma_f32_16x16x32_bf16 v[92:95], a[240:243], v[116:119], v[92:95]
    v_mfma_f32_16x16x32_bf16 v[96:99], a[244:247], v[116:119], v[96:99]
    v_mfma_f32_16x16x32_bf16 v[100:103], a[248:251], v[116:119], v[100:103]
    s_waitcnt vmcnt(9)
    v_mfma_f32_16x16x32_bf16 v[84:87], a[252:255], v[120:123], v[84:87]
    v_mfma_f32_16x16x32_bf16 v[88:91], v[164:167], v[120:123], v[88:91]
    v_mfma_f32_16x16x32_bf16 v[92:95], a[0:3], v[120:123], v[92:95]
    v_mfma_f32_16x16x32_bf16 v[96:99], a[4:7], v[120:123], v[96:99]
    v_mfma_f32_16x16x32_bf16 v[100:103], a[8:11], v[120:123], v[100:103]
    s_waitcnt vmcnt(8)
    v_mfma_f32_16x16x32_bf16 v[84:87], a[12:15], v[124:127], v[84:87]
    v_mfma_f32_16x16x32_bf16 v[88:91], a[16:19], v[124:127], v[88:91]
    v_mfma_f32_16x16x32_bf16 v[92:95], a[20:23], v[124:127], v[92:95]
    v_mfma_f32_16x16x32_bf16 v[96:99], a[24:27], v[124:127], v[96:99]
    v_mfma_f32_16x16x32_bf16 v[100:103], a[28:31], v[124:127], v[100:103]
    s_waitcnt lgkmcnt(0)
    s_barrier
    s_waitcnt vmcnt(7)
    v_mfma_f32_16x16x32_bf16 v[84:87], a[32:35], v[128:131], v[84:87]
    ds_read_b128 v[64:67], v161 offset:0
    v_mfma_f32_16x16x32_bf16 v[88:91], a[36:39], v[128:131], v[88:91]
    ds_read_b128 v[68:71], v161 offset:1024
    v_mfma_f32_16x16x32_bf16 v[92:95], a[40:43], v[128:131], v[92:95]
    ds_read_b128 v[72:75], v161 offset:2048
    v_mfma_f32_16x16x32_bf16 v[96:99], a[44:47], v[128:131], v[96:99]
    ds_read_b128 v[76:79], v161 offset:3072
    v_mfma_f32_16x16x32_bf16 v[100:103], a[48:51], v[128:131], v[100:103]
    ds_read_b128 v[80:83], v161 offset:4096
    s_waitcnt vmcnt(6)
    v_mfma_f32_16x16x32_bf16 v[84:87], a[52:55], v[132:135], v[84:87]
    v_mfma_f32_16x16x32_bf16 v[88:91], a[56:59], v[132:135], v[88:91]
    v_mfma_f32_16x16x32_bf16 v[92:95], a[60:63], v[132:135], v[92:95]
    v_mfma_f32_16x16x32_bf16 v[96:99], a[64:67], v[132:135], v[96:99]
    v_mfma_f32_16x16x32_bf16 v[100:103], a[68:71], v[132:135], v[100:103]
    s_waitcnt vmcnt(5)
    v_mfma_f32_16x16x32_bf16 v[84:87], a[72:75], v[136:139], v[84:87]
    v_mfma_f32_16x16x32_bf16 v[88:91], a[76:79], v[136:139], v[88:91]
    v_mfma_f32_16x16x32_bf16 v[92:95], a[80:83], v[136:139], v[92:95]
    v_mfma_f32_16x16x32_bf16 v[96:99], a[84:87], v[136:139], v[96:99]
    v_mfma_f32_16x16x32_bf16 v[100:103], a[88:91], v[136:139], v[100:103]
    s_waitcnt vmcnt(4)
    v_mfma_f32_16x16x32_bf16 v[84:87], a[92:95], v[140:143], v[84:87]
    v_mfma_f32_16x16x32_bf16 v[88:91], a[96:99], v[140:143], v[88:91]
    v_mfma_f32_16x16x32_bf16 v[92:95], a[168:171], v[140:143], v[92:95]
    v_mfma_f32_16x16x32_bf16 v[96:99], v[168:171], v[140:143], v[96:99]
    v_mfma_f32_16x16x32_bf16 v[100:103], v[172:175], v[140:143], v[100:103]
    s_waitcnt vmcnt(3)
    v_mfma_f32_16x16x32_bf16 v[84:87], v[176:179], v[144:147], v[84:87]
    v_mfma_f32_16x16x32_bf16 v[88:91], v[180:183], v[144:147], v[88:91]
    v_mfma_f32_16x16x32_bf16 v[92:95], v[184:187], v[144:147], v[92:95]
    v_mfma_f32_16x16x32_bf16 v[96:99], v[188:191], v[144:147], v[96:99]
    v_mfma_f32_16x16x32_bf16 v[100:103], v[192:195], v[144:147], v[100:103]
    s_waitcnt vmcnt(2)
    v_mfma_f32_16x16x32_bf16 v[84:87], v[196:199], v[148:151], v[84:87]
    v_mfma_f32_16x16x32_bf16 v[88:91], v[200:203], v[148:151], v[88:91]
    v_mfma_f32_16x16x32_bf16 v[92:95], v[204:207], v[148:151], v[92:95]
    v_mfma_f32_16x16x32_bf16 v[96:99], v[208:211], v[148:151], v[96:99]
    v_mfma_f32_16x16x32_bf16 v[100:103], v[212:215], v[148:151], v[100:103]
    s_waitcnt vmcnt(1)
    v_mfma_f32_16x16x32_bf16 v[84:87], v[216:219], v[152:155], v[84:87]
    v_mfma_f32_16x16x32_bf16 v[88:91], v[220:223], v[152:155], v[88:91]
    v_mfma_f32_16x16x32_bf16 v[92:95], v[224:227], v[152:155], v[92:95]
    v_mfma_f32_16x16x32_bf16 v[96:99], v[228:231], v[152:155], v[96:99]
    v_mfma_f32_16x16x32_bf16 v[100:103], v[232:235], v[152:155], v[100:103]
    s_waitcnt vmcnt(0)
    v_mfma_f32_16x16x32_bf16 v[84:87], v[236:239], v[156:159], v[84:87]
    v_mfma_f32_16x16x32_bf16 v[88:91], v[240:243], v[156:159], v[88:91]
    v_mfma_f32_16x16x32_bf16 v[92:95], v[244:247], v[156:159], v[92:95]
    v_mfma_f32_16x16x32_bf16 v[96:99], v[248:251], v[156:159], v[96:99]
    v_mfma_f32_16x16x32_bf16 v[100:103], v[252:255], v[156:159], v[100:103]
    ds_read_b128 v[104:107], v161 offset:5120
    ds_read_b128 v[108:111], v161 offset:6144
    ds_read_b128 v[112:115], v161 offset:7168
    ds_read_b128 v[116:119], v161 offset:8192
    ds_read_b128 v[120:123], v161 offset:9216
    ds_read_b128 v[124:127], v161 offset:10240
    ds_read_b128 v[128:131], v161 offset:11264
    ds_read_b128 v[132:135], v161 offset:12288
    ds_read_b128 v[136:139], v161 offset:13312
    ds_read_b128 v[140:143], v161 offset:14336
    s_add_u32 s58, s62, 16384
    buffer_load_dwordx4 a[168:171], v1, s[16:19], s58 offen offset:1024
    buffer_load_dwordx4 a[172:175], v1, s[16:19], s58 offen offset:2048
    buffer_load_dwordx4 a[176:179], v1, s[16:19], s58 offen offset:3072
    s_add_u32 s58, s62, 20480
    buffer_load_dwordx4 a[180:183], v1, s[16:19], s58 offen offset:0
    v_and_b32 v144, 15, v0
    v_lshlrev_b32 v144, 4, v144
    v_lshrrev_b32 v145, 5, v0
    v_lshl_add_u32 v144, v145, 8, v144
    v_bfe_u32 v145, v0, 4, 1
    v_lshl_add_u32 v144, v145, 3, v144
    v_lshlrev_b32 v145, 3, v0
    v_mov_b32 v146, 0x40000000
    v_cmp_gt_u32 vcc, 16, v0
    s_nop 1
    v_cndmask_b32 v145, v146, v145, vcc
    s_waitcnt lgkmcnt(10)
    v_pk_add_f32 v[84:85], v[84:85], v[64:65]
    v_pk_add_f32 v[86:87], v[86:87], v[66:67]
    v_pk_add_f32 v[88:89], v[88:89], v[68:69]
    v_pk_add_f32 v[90:91], v[90:91], v[70:71]
    v_pk_add_f32 v[92:93], v[92:93], v[72:73]
    v_pk_add_f32 v[94:95], v[94:95], v[74:75]
    v_pk_add_f32 v[96:97], v[96:97], v[76:77]
    v_pk_add_f32 v[98:99], v[98:99], v[78:79]
    v_pk_add_f32 v[100:101], v[100:101], v[80:81]
    v_pk_add_f32 v[102:103], v[102:103], v[82:83]
    s_waitcnt lgkmcnt(5)
    v_pk_add_f32 v[84:85], v[84:85], v[104:105]
    v_pk_add_f32 v[86:87], v[86:87], v[106:107]
    v_pk_add_f32 v[88:89], v[88:89], v[108:109]
    v_pk_add_f32 v[90:91], v[90:91], v[110:111]
    v_pk_add_f32 v[92:93], v[92:93], v[112:113]
    v_pk_add_f32 v[94:95], v[94:95], v[114:115]
    v_pk_add_f32 v[96:97], v[96:97], v[116:117]
    v_pk_add_f32 v[98:99], v[98:99], v[118:119]
    v_pk_add_f32 v[100:101], v[100:101], v[120:121]
    v_pk_add_f32 v[102:103], v[102:103], v[122:123]
    s_waitcnt lgkmcnt(0)
    v_pk_add_f32 v[84:85], v[84:85], v[124:125]
    v_pk_add_f32 v[86:87], v[86:87], v[126:127]
    v_pk_add_f32 v[88:89], v[88:89], v[128:129]
    v_pk_add_f32 v[90:91], v[90:91], v[130:131]
    v_pk_add_f32 v[92:93], v[92:93], v[132:133]
    v_pk_add_f32 v[94:95], v[94:95], v[134:135]
    v_pk_add_f32 v[96:97], v[96:97], v[136:137]
    v_pk_add_f32 v[98:99], v[98:99], v[138:139]
    v_pk_add_f32 v[100:101], v[100:101], v[140:141]
    v_pk_add_f32 v[102:103], v[102:103], v[142:143]
    v_cvt_pk_bf16_f32 v36, v84, v85
    v_cvt_pk_bf16_f32 v37, v86, v87
    v_cvt_pk_bf16_f32 v38, v88, v89
    v_cvt_pk_bf16_f32 v39, v90, v91
    v_cvt_pk_bf16_f32 v40, v92, v93
    v_cvt_pk_bf16_f32 v41, v94, v95
    v_cvt_pk_bf16_f32 v42, v96, v97
    v_cvt_pk_bf16_f32 v43, v98, v99
    v_cvt_pk_bf16_f32 v44, v100, v101
    v_cvt_pk_bf16_f32 v45, v102, v103
    s_cmp_eq_u32 s24, 1
    s_cbranch_scc1 final_47
    buffer_store_dwordx4 v[36:39], v1, s[4:7], s36 offen sc1
    buffer_store_dwordx4 v[40:43], v1, s[4:7], s36 offen offset:1024 sc1
    buffer_store_dwordx2 v[44:45], v144, s[4:7], s36 offen offset:2048 sc1
    s_mov_b32 s39, 0x3f803f80
    v_dot2_f32_bf16 v64, v36, s39, 0
    v_dot2_f32_bf16 v65, v36, v36, 0
    v_dot2_f32_bf16 v64, v37, s39, v64
    v_dot2_f32_bf16 v65, v37, v37, v65
    v_dot2_f32_bf16 v64, v38, s39, v64
    v_dot2_f32_bf16 v65, v38, v38, v65
    v_dot2_f32_bf16 v64, v39, s39, v64
    v_dot2_f32_bf16 v65, v39, v39, v65
    v_dot2_f32_bf16 v64, v40, s39, v64
    v_dot2_f32_bf16 v65, v40, v40, v65
    v_dot2_f32_bf16 v64, v41, s39, v64
    v_dot2_f32_bf16 v65, v41, v41, v65
    v_dot2_f32_bf16 v64, v42, s39, v64
    v_dot2_f32_bf16 v65, v42, v42, v65
    v_dot2_f32_bf16 v64, v43, s39, v64
    v_dot2_f32_bf16 v65, v43, v43, v65
    v_dot2_f32_bf16 v64, v44, s39, v64
    v_dot2_f32_bf16 v65, v44, v44, v65
    v_dot2_f32_bf16 v64, v45, s39, v64
    v_dot2_f32_bf16 v65, v45, v45, v65
    s_nop 1
    v_mov_b32 v66, v64
    v_mov_b32 v67, v65
    s_nop 0
    v_permlane16_swap_b32 v64, v66
    v_permlane16_swap_b32 v65, v67
    v_pk_add_f32 v[64:65], v[64:65], v[66:67]
    v_mov_b32 v66, v64
    v_mov_b32 v67, v65
    s_nop 0
    v_permlane32_swap_b32 v64, v66
    v_permlane32_swap_b32 v65, v67
    v_pk_add_f32 v[64:65], v[64:65], v[66:67]
    buffer_store_dwordx2 v[64:65], v145, s[4:7], s37 offen sc1
    s_add_u32 s95, s95, 1
    v_mov_b32 v162, s95
    s_mov_b64 exec, 1
    s_cmp_eq_u32 s23, 0
    s_cbranch_scc1 slow_48
    s_waitcnt vmcnt(0)
    buffer_store_dword v162, v63, s[4:7], s60 offen
    s_branch join_49
    s_nop 0
slow_48:
    s_waitcnt vmcnt(0)
    buffer_store_dword v162, v63, s[4:7], s60 offen sc1
    s_nop 1
join_49:
    s_mov_b64 exec, -1
    s_mov_b64 exec, 1
    buffer_store_dword v162, v63, s[4:7], s38 offen sc1
    s_mov_b64 exec, -1
    buffer_load_dwordx4 a[184:187], v1, s[16:19], s58 offen offset:1024
    buffer_load_dwordx4 a[188:191], v1, s[16:19], s58 offen offset:2048
    buffer_load_dwordx4 a[192:195], v1, s[16:19], s58 offen offset:3072
    s_add_u32 s58, s62, 24576
    buffer_load_dwordx4 a[196:199], v1, s[16:19], s58 offen offset:0
    s_mov_b32 s24, 1
    s_mov_b32 s91, 5242880
    s_mov_b32 s18, 0
    s_add_u32 s93, s93, 5242880
    s_add_u32 s94, s94, 262144
    s_branch pass_loop
    s_nop 0
final_47:
    v_and_b32 v64, 15, v0
    v_mul_u32_u24 v64, 2560, v64
    v_lshrrev_b32 v65, 4, v0
    v_lshl_add_u32 v64, v65, 3, v64
    buffer_store_dwordx2 v[36:37], v64, s[12:15], s32 offen offset:0
    buffer_store_dwordx2 v[38:39], v64, s[12:15], s32 offen offset:32
    buffer_store_dwordx2 v[40:41], v64, s[12:15], s32 offen offset:64
    buffer_store_dwordx2 v[42:43], v64, s[12:15], s32 offen offset:96
    buffer_store_dwordx2 v[44:45], v64, s[12:15], s32 offen offset:128
    s_nop 1
k_end:
    s_endpgm
code_end:
.section .rodata,"a"
.p2align 6
.amdhsa_kernel interleave_layers__sliding_local_dilated__dense_activation_squared_relu__prompt_kernel
  .amdhsa_next_free_vgpr 512
  .amdhsa_next_free_sgpr 102
  .amdhsa_accum_offset 256
  .amdhsa_group_segment_fixed_size 0
  .amdhsa_kernarg_size 88
  .amdhsa_user_sgpr_count 2
  .amdhsa_user_sgpr_kernarg_segment_ptr 1
  .amdhsa_system_sgpr_workgroup_id_x 1
.end_amdhsa_kernel
```
